```python
import torch

def _softmax(x, axis=-1):
    return torch.softmax(x, dim=axis)
def _gelu(x):
    return torch.nn.functional.gelu(x, approximate="tanh")
def _silu(x):
    return torch.nn.functional.silu(x)
def _sigmoid(x):
    return torch.sigmoid(x)
def _layernorm(x, axis=-1, eps=1e-5):
    m = x.mean(dim=axis, keepdim=True)
    v = x.var(dim=axis, keepdim=True, unbiased=False)
    return (x - m) / torch.sqrt(v + eps)
def _scatter_add(tgt, idx, src, axis=0):
    return tgt.clone().index_add_(axis, idx, src)
def _segment_sum(src, seg, n):
    out = torch.zeros((n,) + src.shape[1:], dtype=src.dtype)
    return out.index_add_(0, seg, src)
def _pad(x, pw):
    flat = tuple(v for pair in reversed(pw) for v in pair)
    return torch.nn.functional.pad(x, flat)

kernel_name = 'parallel_sum__grouped_kv_mqa__mixer_token_mlp__prompt'

def setup_inputs():

    _w = (lambda a: (lambda t: t.to(torch.bfloat16) if t.is_floating_point() else t)(torch.as_tensor(a)))
    def _A_setup():
        B, S, D, H = 1, 2048, 640, 32
        Dh = D // H
        return {
            "x": _w((lambda *s: torch.randn(*s, dtype=torch.bfloat16) * 0.05)(B, S, D)),
            "wq": _w((lambda *s: torch.randn(*s, dtype=torch.bfloat16) * 0.05)(D, H * Dh)),
            "wk": _w((lambda *s: torch.randn(*s, dtype=torch.bfloat16) * 0.05)(D, Dh)),
            "wv": _w((lambda *s: torch.randn(*s, dtype=torch.bfloat16) * 0.05)(D, Dh)),
            "wo": _w((lambda *s: torch.randn(*s, dtype=torch.bfloat16) * 0.05)(H * Dh, D)),
        }
    _A_in = _A_setup()

    def _B_setup():
        B, S, D, F = 1, 2048, 640, 1536
        return {
            "x": _w((lambda *s: torch.randn(*s, dtype=torch.bfloat16) * 0.05)(B, S, D)),
            "w1": _w((lambda *s: torch.randn(*s, dtype=torch.bfloat16) * 1.6)(S, F) * (S ** -0.5)),
            "b1": _w((lambda *s: torch.randn(*s, dtype=torch.bfloat16) * 12.8)(F) * 0.02),
            "w2": _w((lambda *s: torch.randn(*s, dtype=torch.bfloat16) * 0.8)(F, S) * (F ** -0.5)),
            "b2": _w((lambda *s: torch.randn(*s, dtype=torch.bfloat16) * 12.8)(S) * 0.02),
        }
    _B_in = _B_setup()

    return {
        "A_x": _A_in["x"],
        "A_wq": _A_in["wq"],
        "A_wk": _A_in["wk"],
        "A_wv": _A_in["wv"],
        "A_wo": _A_in["wo"],
        "B_x": _B_in["x"],
        "B_w1": _B_in["w1"],
        "B_b1": _B_in["b1"],
        "B_w2": _B_in["w2"],
        "B_b2": _B_in["b2"],
    }

def reference(A_x, A_wq, A_wk, A_wv, A_wo, B_x, B_w1, B_b1, B_w2, B_b2):
    def _A_ref(x, wq, wk, wv, wo):
        B, S, D = x.shape
        H = 32
        Dh = D // H
        q = (lambda x, *d: x.permute(*d))((x @ wq).reshape(B, S, H, Dh), 0, 2, 1, 3)
        k = x @ wk
        v = x @ wv
        scores = torch.einsum("bhqd,bkd->bhqk", q, k) * (Dh ** -0.5)
        p = _softmax(scores, axis=-1)
        o = torch.einsum("bhqk,bkd->bhqd", p, v)
        return (lambda x, *d: x.permute(*d))(o, 0, 2, 1, 3).reshape(B, S, H * Dh) @ wo

    def _B_ref(x, w1, b1, w2, b2):
        B, S, D = x.shape
        h = _layernorm(x, axis=-1)
        u = torch.einsum("bsd,sf->bdf", h, w1) + b1
        u = _gelu(u)
        y = torch.einsum("bdf,fs->bds", u, w2) + b2
        return (lambda x, *d: x.permute(*d))(y, 0, 2, 1)

    x = A_x
    xn = _layernorm(x, axis=-1)
    return x + _A_ref(xn, A_wq, A_wk, A_wv, A_wo) + _B_ref(xn, B_w1, B_b1, B_w2, B_b2)
```

```asm
; @launch grid=(512,1,1) block=(256,1,1) lds=81920
.amdgcn_target "amdgcn-amd-amdhsa--gfx950"
.text
.globl parallel_sum__grouped_kv_mqa__mixer_token_mlp__prompt_kernel
.p2align 8
.type parallel_sum__grouped_kv_mqa__mixer_token_mlp__prompt_kernel,@function
parallel_sum__grouped_kv_mqa__mixer_token_mlp__prompt_kernel:
    s_cmp_ge_u32 s2, 512
    s_cbranch_scc1 parallel_sum__grouped_kv_mqa__mixer_token_mlp__prompt_kernel_end
    s_load_dwordx16 s[8:23], s[0:1], 0
    s_load_dwordx8 s[24:31], s[0:1], 64
    s_load_dwordx2 s[32:33], s[0:1], 96
    s_getpc_b64 s[76:77]
PC_1:
    s_lshr_b32 s78, s2, 3
    s_lshl_b32 s78, s78, 2
    v_lshrrev_b32 v252, 6, v0
    v_add_u32 v252, s78, v252
    v_lshlrev_b32 v252, 7, v252
    v_min_u32 v252, parallel_sum__grouped_kv_mqa__mixer_token_mlp__prompt_kernel_end-PC_1, v252
    global_load_dword v253, v252, s[76:77]
    s_xor_b32 s2, s2, 256
    s_cmp_ge_u32 s2, 256
    s_cbranch_scc1 parallel_sum__grouped_kv_mqa__mixer_token_mlp__prompt_kernel_m
    s_setprio 0
    s_and_b32 s35, s2, 7
    s_lshr_b32 s64, s2, 3
    s_and_b32 s36, s64, 7
    s_lshr_b32 s64, s64, 3
    s_lshl_b32 s64, s64, 3
    s_add_u32 s35, s35, s64
    v_lshrrev_b32 v1, 6, v0
    s_nop 0
    v_readfirstlane_b32 s4, v1
    v_and_b32 v1, 63, v0
    v_lshrrev_b32 v2, 5, v1
    v_and_b32 v3, 31, v1
    s_nop 2
    s_lshl_b32 s37, s36, 2
    s_add_u32 s37, s37, s4
    s_and_b32 s5, s4, 1
    s_lshl_b32 s38, s35, 1
    s_add_u32 s39, s38, 1
    s_sub_u32 s39, s39, s5
    s_add_u32 s38, s38, s5
    v_lshrrev_b32 v20, 2, v1
    s_lshl_b32 s64, s35, 6
    s_lshl_b32 s65, s4, 4
    s_add_u32 s64, s64, s65
    v_add_u32 v20, s64, v20
    s_movk_i32 s66, 1280
    v_mul_lo_u32 v20, v20, s66
    v_and_b32 v21, 3, v1
    v_bfe_u32 v22, v1, 4, 2
    v_xor_b32 v21, v21, v22
    v_lshl_add_u32 v4, v21, 4, v20
    s_add_u32 s72, s4, 4
    s_add_u32 s73, s4, 8
    s_cmp_lt_u32 s4, 2
    s_cselect_b32 s73, s73, s72
    s_mov_b32 s71, s4
    s_mul_i32 s65, s36, 160
    s_lshl_b32 s64, s71, 6
    v_add_u32 v20, s64, v1
    v_mul_u32_u24 v21, 6554, v20
    v_lshrrev_b32 v21, 16, v21
    v_mul_u32_u24 v22, 10, v21
    v_sub_u32 v22, v20, v22
    v_mul_lo_u32 v21, v21, s66
    v_lshl_add_u32 v21, v22, 4, v21
    v_add_u32 v5, s65, v21
    s_lshl_b32 s71, s71, 10
    s_add_u32 s71, s71, 8192
    s_lshl_b32 s64, s72, 6
    v_add_u32 v20, s64, v1
    v_mul_u32_u24 v21, 6554, v20
    v_lshrrev_b32 v21, 16, v21
    v_mul_u32_u24 v22, 10, v21
    v_sub_u32 v22, v20, v22
    v_mul_lo_u32 v21, v21, s66
    v_lshl_add_u32 v21, v22, 4, v21
    v_add_u32 v6, s65, v21
    s_lshl_b32 s72, s72, 10
    s_add_u32 s72, s72, 8192
    s_lshl_b32 s64, s73, 6
    v_add_u32 v20, s64, v1
    v_mul_u32_u24 v21, 6554, v20
    v_lshrrev_b32 v21, 16, v21
    v_mul_u32_u24 v22, 10, v21
    v_sub_u32 v22, v20, v22
    v_mul_lo_u32 v21, v21, s66
    v_lshl_add_u32 v21, v22, 4, v21
    v_add_u32 v7, s65, v21
    s_lshl_b32 s73, s73, 10
    s_add_u32 s73, s73, 8192
    s_cmp_lt_u32 s4, 2
    s_cselect_b32 s73, s73, 77824
    v_lshrrev_b32 v20, 4, v3
    s_lshl_b32 s64, s5, 1
    v_add_u32 v20, s64, v20
    v_lshlrev_b32 v20, 10, v20
    v_and_b32 v21, 15, v3
    v_lshl_add_u32 v20, v21, 6, v20
    v_bfe_u32 v21, v3, 2, 2
    v_xor_b32 v21, v21, v2
    v_lshl_add_u32 v20, v21, 4, v20
    v_add_u32 v8, 0, v20
    v_xor_b32 v9, 32, v8
    s_cmp_eq_u32 s5, 0
    s_movk_i32 s65, -2048
    s_cselect_b32 s64, 2048, s65
    v_add_u32 v10, s64, v8
    v_add_u32 v11, s64, v9
    v_and_b32 v21, 3, v1
    v_bfe_u32 v22, v1, 4, 1
    v_lshl_add_u32 v21, v22, 2, v21
    v_lshrrev_b32 v22, 1, v21
    v_xor_b32 v22, v22, v21
    v_and_b32 v22, 1, v22
    v_mul_u32_u24 v22, 3, v22
    v_xor_b32 v22, v22, v21
    v_cmp_gt_u32 vcc, 4, v21
    v_mov_b32 v23, 4
    s_nop 0
    v_cndmask_b32 v23, v23, v22, vcc
    v_bfe_u32 v20, v1, 2, 2
    v_lshl_add_u32 v20, v2, 3, v20
    v_mul_u32_u24 v20, 160, v20
    v_lshl_add_u32 v20, v23, 3, v20
    s_mul_i32 s64, s4, 40
    s_add_u32 s64, s64, 8192
    v_add_u32 v12, s64, v20
    v_mov_b32 v16, 0x3f803f80
    v_mov_b32 v17, 0x3f803f80
    v_mov_b32 v18, 0x3f803f80
    v_mov_b32 v19, 0x3f803f80
    v_mov_b32 v48, 0
    v_mov_b32 v49, 0
    v_mov_b32 v50, 0
    v_mov_b32 v51, 0
    v_mov_b32 v52, 0
    v_mov_b32 v53, 0
    v_mov_b32 v54, 0
    v_mov_b32 v55, 0
    v_mov_b32 v56, 0
    v_mov_b32 v57, 0
    v_mov_b32 v58, 0
    v_mov_b32 v59, 0
    v_mov_b32 v60, 0
    v_mov_b32 v61, 0
    v_mov_b32 v62, 0
    v_mov_b32 v63, 0
    v_mov_b32 v64, 0
    v_mov_b32 v65, 0
    v_mov_b32 v66, 0
    v_mov_b32 v67, 0
    v_mov_b32 v68, 0
    v_mov_b32 v69, 0
    v_mov_b32 v70, 0
    v_mov_b32 v71, 0
    v_mov_b32 v72, 0
    v_mov_b32 v73, 0
    v_mov_b32 v74, 0
    v_mov_b32 v75, 0
    v_mov_b32 v76, 0
    v_mov_b32 v77, 0
    v_mov_b32 v78, 0
    v_mov_b32 v79, 0
    v_mov_b32 v96, 0
    v_mov_b32 v97, 0
    v_mov_b32 v98, 0
    v_mov_b32 v99, 0
    v_mov_b32 v100, 0
    v_mov_b32 v101, 0
    v_mov_b32 v102, 0
    v_mov_b32 v103, 0
    v_mov_b32 v104, 0
    v_mov_b32 v105, 0
    v_mov_b32 v106, 0
    v_mov_b32 v107, 0
    v_mov_b32 v108, 0
    v_mov_b32 v109, 0
    v_mov_b32 v110, 0
    v_mov_b32 v111, 0
    s_mov_b32 s6, 0x3f803f80
    s_mov_b32 s60, 0
    s_mov_b32 s63, 0
    v_lshlrev_b32 v240, 4, v1
    v_lshlrev_b32 v242, 3, v3
    v_add_u32 v242, 8192, v242
    v_min_u32 v20, 21, v3
    v_lshlrev_b32 v20, 4, v20
    v_mul_u32_u24 v21, 384, v2
    v_add_u32 v20, v20, v21
    v_add_u32 v244, 10240, v20
    v_add_u32 v241, 4096, v240
    v_add_u32 v240, 36864, v240
    v_add_u32 v243, 4096, v242
    v_add_u32 v242, 36864, v242
    v_add_u32 v245, 4096, v244
    v_add_u32 v244, 36864, v244
    s_mul_i32 s64, s4, 6144
    v_lshlrev_b32 v246, 4, v1
    v_add_u32 v246, s64, v246
    v_mov_b32 v160, 0
    v_mov_b32 v161, 0
    v_mov_b32 v162, 0
    v_mov_b32 v163, 0
    v_mov_b32 v164, 0
    v_mov_b32 v165, 0
    v_mov_b32 v166, 0
    v_mov_b32 v167, 0
    v_mov_b32 v168, 0
    v_mov_b32 v169, 0
    v_mov_b32 v170, 0
    v_mov_b32 v171, 0
    v_mov_b32 v172, 0
    v_mov_b32 v173, 0
    v_mov_b32 v174, 0
    v_mov_b32 v175, 0
    v_mov_b32 v176, 0
    v_mov_b32 v177, 0
    v_mov_b32 v178, 0
    v_mov_b32 v179, 0
    v_mov_b32 v180, 0
    v_mov_b32 v181, 0
    v_mov_b32 v182, 0
    v_mov_b32 v183, 0
    v_mov_b32 v184, 0
    v_mov_b32 v185, 0
    v_mov_b32 v186, 0
    v_mov_b32 v187, 0
    v_mov_b32 v188, 0
    v_mov_b32 v189, 0
    v_mov_b32 v190, 0
    v_mov_b32 v191, 0
    v_mov_b32 v128, 0
    v_mov_b32 v129, 0
    v_mov_b32 v130, 0
    v_mov_b32 v131, 0
    v_mov_b32 v132, 0
    v_mov_b32 v133, 0
    v_mov_b32 v134, 0
    v_mov_b32 v135, 0
    v_mov_b32 v136, 0
    v_mov_b32 v137, 0
    v_mov_b32 v138, 0
    v_mov_b32 v139, 0
    v_mov_b32 v140, 0
    v_mov_b32 v141, 0
    v_mov_b32 v142, 0
    v_mov_b32 v143, 0
    v_mov_b32 v144, 0
    v_mov_b32 v145, 0
    v_mov_b32 v146, 0
    v_mov_b32 v147, 0
    v_mov_b32 v148, 0
    v_mov_b32 v149, 0
    v_mov_b32 v150, 0
    v_mov_b32 v151, 0
    v_mov_b32 v152, 0
    v_mov_b32 v153, 0
    v_mov_b32 v154, 0
    v_mov_b32 v155, 0
    v_mov_b32 v156, 0
    v_mov_b32 v157, 0
    v_mov_b32 v158, 0
    v_mov_b32 v159, 0
    v_mov_b32 v192, 0
    v_mov_b32 v193, 0
    v_mov_b32 v194, 0
    v_mov_b32 v195, 0
    v_mov_b32 v196, 0
    v_mov_b32 v197, 0
    v_mov_b32 v198, 0
    v_mov_b32 v199, 0
    v_mov_b32 v200, 0
    v_mov_b32 v201, 0
    v_mov_b32 v202, 0
    v_mov_b32 v203, 0
    v_mov_b32 v204, 0
    v_mov_b32 v205, 0
    v_mov_b32 v206, 0
    v_mov_b32 v207, 0
    v_mov_b32 v236, 0
    v_mov_b32 v237, 0
    v_mov_b32 v238, 0
    v_mov_b32 v239, 0
    s_waitcnt lgkmcnt(0)
    s_mov_b32 s40, s8
    s_mov_b32 s41, s9
    s_mov_b32 s42, 0x280000
    s_mov_b32 s43, 0x20000
    s_mov_b32 s44, s10
    s_mov_b32 s45, s11
    s_mov_b32 s46, 0xc8000
    s_mov_b32 s47, 0x20000
    s_lshl_b32 s77, s4, 10
    s_mov_b32 s66, 0
    s_mov_b32 s61, 0
    s_lshl_b32 s74, s66, 7
    s_cmp_lt_u32 s66, 10
    s_cselect_b32 s74, s74, 0x40000000
    s_mul_i32 s75, s66, 81920
    s_add_u32 s76, s61, s77
    s_cmp_lt_u32 s4, 2
    s_cselect_b32 s98, s61, 0
    s_cselect_b32 s99, s75, 0x40000000
    s_mov_b32 m0, s76
    s_add_u32 s64, s74, 64
    buffer_load_dwordx4 v4, s[40:43], s74 offen lds
    s_add_u32 m0, s76, 4096
    s_nop 0
    buffer_load_dwordx4 v4, s[40:43], s64 offen lds
    s_add_u32 m0, s61, s71
    s_nop 0
    buffer_load_dwordx4 v5, s[44:47], s75 offen lds
    s_add_u32 m0, s61, s72
    s_nop 0
    buffer_load_dwordx4 v6, s[44:47], s75 offen lds
    s_add_u32 m0, s98, s73
    s_nop 0
    buffer_load_dwordx4 v7, s[44:47], s99 offen lds
    s_mov_b32 s66, 1
    s_mov_b32 s61, 18432
    s_lshl_b32 s74, s66, 7
    s_cmp_lt_u32 s66, 10
    s_cselect_b32 s74, s74, 0x40000000
    s_mul_i32 s75, s66, 81920
    s_add_u32 s76, s61, s77
    s_cmp_lt_u32 s4, 2
    s_cselect_b32 s98, s61, 0
    s_cselect_b32 s99, s75, 0x40000000
    s_mov_b32 m0, s76
    s_add_u32 s64, s74, 64
    buffer_load_dwordx4 v4, s[40:43], s74 offen lds
    s_add_u32 m0, s76, 4096
    s_nop 0
    buffer_load_dwordx4 v4, s[40:43], s64 offen lds
    s_add_u32 m0, s61, s71
    s_nop 0
    buffer_load_dwordx4 v5, s[44:47], s75 offen lds
    s_add_u32 m0, s61, s72
    s_nop 0
    buffer_load_dwordx4 v6, s[44:47], s75 offen lds
    s_add_u32 m0, s98, s73
    s_nop 0
    buffer_load_dwordx4 v7, s[44:47], s99 offen lds
    s_add_u32 s48, s32, 0x10000
    s_addc_u32 s49, s33, 0
    s_mov_b32 s50, 0x2c000
    s_mov_b32 s51, 0x20000
    s_lshr_b32 s64, s2, 3
    s_mul_i32 s64, s64, 20
    s_mul_i32 s65, s4, 5
    s_add_u32 s64, s64, s65
    v_mul_u32_u24 v20, 6554, v1
    v_lshrrev_b32 v20, 16, v20
    v_mul_u32_u24 v21, 10, v20
    v_sub_u32 v21, v1, v21
    v_lshlrev_b32 v21, 7, v21
    v_add_u32 v22, s64, v20
    v_mul_u32_u24 v22, 1280, v22
    v_add_u32 v22, v22, v21
    s_mov_b32 exec_hi, 0x3ffff
    buffer_load_dword v255, v22, s[44:47], 0 offen
    s_lshl_b32 s64, s35, 6
    s_lshl_b32 s65, s36, 3
    s_add_u32 s64, s64, s65
    s_lshl_b32 s65, s4, 1
    s_add_u32 s64, s64, s65
    s_mov_b32 exec_hi, 0
    s_mov_b32 exec_lo, 0xfffff
    v_add_u32 v22, s64, v20
    v_mul_u32_u24 v22, 1280, v22
    v_add_u32 v22, v22, v21
    buffer_load_dword v255, v22, s[40:43], 0 offen
    s_mov_b64 exec, -1
    s_setprio 0
    s_waitcnt vmcnt(7)
    s_barrier
    ds_read_b64_tr_b16 v[20:21], v12 offset:0
    ds_read_b64_tr_b16 v[22:23], v12 offset:640
    ds_read_b128 v[24:27], v8 offset:0
    ds_read_b128 v[28:31], v10 offset:0
    ds_read_b64_tr_b16 v[32:33], v12 offset:2560
    ds_read_b64_tr_b16 v[34:35], v12 offset:3200
    ds_read_b128 v[36:39], v9 offset:0
    ds_read_b128 v[40:43], v11 offset:0
QP_top_4:
    s_add_u32 s66, s60, 2
    s_add_u32 s61, s63, 2
    s_and_b32 s61, s61, 3
    s_mul_i32 s61, s61, 18432
    s_lshl_b32 s74, s66, 7
    s_cmp_lt_u32 s66, 10
    s_cselect_b32 s74, s74, 0x40000000
    s_mul_i32 s75, s66, 81920
    s_add_u32 s76, s61, s77
    s_cmp_lt_u32 s4, 2
    s_cselect_b32 s98, s61, 0
    s_cselect_b32 s99, s75, 0x40000000
    ds_read_b64_tr_b16 v[208:209], v12 offset:5120
    ds_read_b64_tr_b16 v[210:211], v12 offset:5760
    ds_read_b128 v[212:215], v8 offset:4096
    ds_read_b128 v[216:219], v10 offset:4096
    s_waitcnt lgkmcnt(8)
    v_mfma_f32_32x32x16_bf16 v[48:63], v[20:23], v[24:27], v[48:63]
    s_mov_b32 m0, s76
    s_add_u32 s64, s74, 64
    buffer_load_dwordx4 v4, s[40:43], s74 offen lds
    v_mfma_f32_32x32x16_bf16 v[64:79], v[20:23], v[28:31], v[64:79]
    s_add_u32 m0, s76, 4096
    s_nop 0
    buffer_load_dwordx4 v4, s[40:43], s64 offen lds
    v_mfma_f32_32x32x16_bf16 v[96:111], v[20:23], v[16:19], v[96:111]
    ds_read_b64_tr_b16 v[220:221], v12 offset:7680
    ds_read_b64_tr_b16 v[222:223], v12 offset:8320
    ds_read_b128 v[224:227], v9 offset:4096
    ds_read_b128 v[228:231], v11 offset:4096
    s_waitcnt lgkmcnt(8)
    v_mfma_f32_32x32x16_bf16 v[48:63], v[32:35], v[36:39], v[48:63]
    s_add_u32 m0, s61, s71
    s_nop 0
    buffer_load_dwordx4 v5, s[44:47], s75 offen lds
    v_mfma_f32_32x32x16_bf16 v[64:79], v[32:35], v[40:43], v[64:79]
    s_add_u32 m0, s61, s72
    s_nop 0
    buffer_load_dwordx4 v6, s[44:47], s75 offen lds
    v_mfma_f32_32x32x16_bf16 v[96:111], v[32:35], v[16:19], v[96:111]
    s_add_u32 m0, s98, s73
    s_nop 0
    buffer_load_dwordx4 v7, s[44:47], s99 offen lds
    s_waitcnt vmcnt(5)
    s_barrier
    s_cmp_eq_u32 s63, 3
    s_mov_b32 s62, 18432
    s_cselect_b32 s62, -55296, s62
    v_add_u32 v8, s62, v8
    v_add_u32 v9, s62, v9
    v_add_u32 v10, s62, v10
    v_add_u32 v11, s62, v11
    v_add_u32 v12, s62, v12
    s_add_u32 s63, s63, 1
    s_and_b32 s63, s63, 3
    s_add_u32 s60, s60, 1
    ds_read_b64_tr_b16 v[20:21], v12 offset:0
    ds_read_b64_tr_b16 v[22:23], v12 offset:640
    ds_read_b128 v[24:27], v8 offset:0
    ds_read_b128 v[28:31], v10 offset:0
    s_waitcnt lgkmcnt(8)
    v_mfma_f32_32x32x16_bf16 v[48:63], v[208:211], v[212:215], v[48:63]
    v_mfma_f32_32x32x16_bf16 v[64:79], v[208:211], v[216:219], v[64:79]
    v_mfma_f32_32x32x16_bf16 v[96:111], v[208:211], v[16:19], v[96:111]
    ds_read_b64_tr_b16 v[32:33], v12 offset:2560
    ds_read_b64_tr_b16 v[34:35], v12 offset:3200
    ds_read_b128 v[36:39], v9 offset:0
    ds_read_b128 v[40:43], v11 offset:0
    s_waitcnt lgkmcnt(8)
    v_mfma_f32_32x32x16_bf16 v[48:63], v[220:223], v[224:227], v[48:63]
    v_mfma_f32_32x32x16_bf16 v[64:79], v[220:223], v[228:231], v[64:79]
    v_mfma_f32_32x32x16_bf16 v[96:111], v[220:223], v[16:19], v[96:111]
    s_add_u32 s66, s60, 2
    s_add_u32 s61, s63, 2
    s_and_b32 s61, s61, 3
    s_mul_i32 s61, s61, 18432
    s_lshl_b32 s74, s66, 7
    s_cmp_lt_u32 s66, 10
    s_cselect_b32 s74, s74, 0x40000000
    s_mul_i32 s75, s66, 81920
    s_add_u32 s76, s61, s77
    s_cmp_lt_u32 s4, 2
    s_cselect_b32 s98, s61, 0
    s_cselect_b32 s99, s75, 0x40000000
    ds_read_b64_tr_b16 v[208:209], v12 offset:5120
    ds_read_b64_tr_b16 v[210:211], v12 offset:5760
    ds_read_b128 v[212:215], v8 offset:4096
    ds_read_b128 v[216:219], v10 offset:4096
    s_waitcnt lgkmcnt(8)
    v_mfma_f32_32x32x16_bf16 v[48:63], v[20:23], v[24:27], v[48:63]
    s_mov_b32 m0, s76
    s_add_u32 s64, s74, 64
    buffer_load_dwordx4 v4, s[40:43], s74 offen lds
    v_mfma_f32_32x32x16_bf16 v[64:79], v[20:23], v[28:31], v[64:79]
    s_add_u32 m0, s76, 4096
    s_nop 0
    buffer_load_dwordx4 v4, s[40:43], s64 offen lds
    v_mfma_f32_32x32x16_bf16 v[96:111], v[20:23], v[16:19], v[96:111]
    ds_read_b64_tr_b16 v[220:221], v12 offset:7680
    ds_read_b64_tr_b16 v[222:223], v12 offset:8320
    ds_read_b128 v[224:227], v9 offset:4096
    ds_read_b128 v[228:231], v11 offset:4096
    s_waitcnt lgkmcnt(8)
    v_mfma_f32_32x32x16_bf16 v[48:63], v[32:35], v[36:39], v[48:63]
    s_add_u32 m0, s61, s71
    s_nop 0
    buffer_load_dwordx4 v5, s[44:47], s75 offen lds
    v_mfma_f32_32x32x16_bf16 v[64:79], v[32:35], v[40:43], v[64:79]
    s_add_u32 m0, s61, s72
    s_nop 0
    buffer_load_dwordx4 v6, s[44:47], s75 offen lds
    v_mfma_f32_32x32x16_bf16 v[96:111], v[32:35], v[16:19], v[96:111]
    s_add_u32 m0, s98, s73
    s_nop 0
    buffer_load_dwordx4 v7, s[44:47], s99 offen lds
    s_waitcnt vmcnt(5)
    s_barrier
    s_cmp_eq_u32 s63, 3
    s_mov_b32 s62, 18432
    s_cselect_b32 s62, -55296, s62
    v_add_u32 v8, s62, v8
    v_add_u32 v9, s62, v9
    v_add_u32 v10, s62, v10
    v_add_u32 v11, s62, v11
    v_add_u32 v12, s62, v12
    s_add_u32 s63, s63, 1
    s_and_b32 s63, s63, 3
    s_add_u32 s60, s60, 1
    ds_read_b64_tr_b16 v[20:21], v12 offset:0
    ds_read_b64_tr_b16 v[22:23], v12 offset:640
    ds_read_b128 v[24:27], v8 offset:0
    ds_read_b128 v[28:31], v10 offset:0
    s_waitcnt lgkmcnt(8)
    v_mfma_f32_32x32x16_bf16 v[48:63], v[208:211], v[212:215], v[48:63]
    v_mfma_f32_32x32x16_bf16 v[64:79], v[208:211], v[216:219], v[64:79]
    v_mfma_f32_32x32x16_bf16 v[96:111], v[208:211], v[16:19], v[96:111]
    ds_read_b64_tr_b16 v[32:33], v12 offset:2560
    ds_read_b64_tr_b16 v[34:35], v12 offset:3200
    ds_read_b128 v[36:39], v9 offset:0
    ds_read_b128 v[40:43], v11 offset:0
    s_waitcnt lgkmcnt(8)
    v_mfma_f32_32x32x16_bf16 v[48:63], v[220:223], v[224:227], v[48:63]
    v_mfma_f32_32x32x16_bf16 v[64:79], v[220:223], v[228:231], v[64:79]
    v_mfma_f32_32x32x16_bf16 v[96:111], v[220:223], v[16:19], v[96:111]
    s_cmp_lt_u32 s60, 6
    s_cbranch_scc1 QP_top_4
    s_add_u32 s66, s60, 2
    s_add_u32 s61, s63, 2
    s_and_b32 s61, s61, 3
    s_mul_i32 s61, s61, 18432
    s_lshl_b32 s74, s66, 7
    s_cmp_lt_u32 s66, 10
    s_cselect_b32 s74, s74, 0x40000000
    s_mul_i32 s75, s66, 81920
    s_add_u32 s76, s61, s77
    s_cmp_lt_u32 s4, 2
    s_cselect_b32 s98, s61, 0
    s_cselect_b32 s99, s75, 0x40000000
    ds_read_b64_tr_b16 v[208:209], v12 offset:5120
    ds_read_b64_tr_b16 v[210:211], v12 offset:5760
    ds_read_b128 v[212:215], v8 offset:4096
    ds_read_b128 v[216:219], v10 offset:4096
    s_waitcnt lgkmcnt(8)
    v_mfma_f32_32x32x16_bf16 v[48:63], v[20:23], v[24:27], v[48:63]
    s_mov_b32 m0, s76
    s_add_u32 s64, s74, 64
    buffer_load_dwordx4 v4, s[40:43], s74 offen lds
    v_mfma_f32_32x32x16_bf16 v[64:79], v[20:23], v[28:31], v[64:79]
    s_add_u32 m0, s76, 4096
    s_nop 0
    buffer_load_dwordx4 v4, s[40:43], s64 offen lds
    v_mfma_f32_32x32x16_bf16 v[96:111], v[20:23], v[16:19], v[96:111]
    ds_read_b64_tr_b16 v[220:221], v12 offset:7680
    ds_read_b64_tr_b16 v[222:223], v12 offset:8320
    ds_read_b128 v[224:227], v9 offset:4096
    ds_read_b128 v[228:231], v11 offset:4096
    s_waitcnt lgkmcnt(8)
    v_mfma_f32_32x32x16_bf16 v[48:63], v[32:35], v[36:39], v[48:63]
    s_add_u32 m0, s61, s71
    s_nop 0
    buffer_load_dwordx4 v5, s[44:47], s75 offen lds
    v_mfma_f32_32x32x16_bf16 v[64:79], v[32:35], v[40:43], v[64:79]
    s_add_u32 m0, s61, s72
    s_nop 0
    buffer_load_dwordx4 v6, s[44:47], s75 offen lds
    v_mfma_f32_32x32x16_bf16 v[96:111], v[32:35], v[16:19], v[96:111]
    s_add_u32 m0, s98, s73
    s_nop 0
    buffer_load_dwordx4 v7, s[44:47], s99 offen lds
    s_waitcnt vmcnt(5)
    s_barrier
    s_cmp_eq_u32 s63, 3
    s_mov_b32 s62, 18432
    s_cselect_b32 s62, -55296, s62
    v_add_u32 v8, s62, v8
    v_add_u32 v9, s62, v9
    v_add_u32 v10, s62, v10
    v_add_u32 v11, s62, v11
    v_add_u32 v12, s62, v12
    s_add_u32 s63, s63, 1
    s_and_b32 s63, s63, 3
    s_add_u32 s60, s60, 1
    ds_read_b64_tr_b16 v[20:21], v12 offset:0
    ds_read_b64_tr_b16 v[22:23], v12 offset:640
    ds_read_b128 v[24:27], v8 offset:0
    ds_read_b128 v[28:31], v10 offset:0
    s_waitcnt lgkmcnt(8)
    v_mfma_f32_32x32x16_bf16 v[48:63], v[208:211], v[212:215], v[48:63]
    v_mfma_f32_32x32x16_bf16 v[64:79], v[208:211], v[216:219], v[64:79]
    v_mfma_f32_32x32x16_bf16 v[96:111], v[208:211], v[16:19], v[96:111]
    ds_read_b64_tr_b16 v[32:33], v12 offset:2560
    ds_read_b64_tr_b16 v[34:35], v12 offset:3200
    ds_read_b128 v[36:39], v9 offset:0
    ds_read_b128 v[40:43], v11 offset:0
    s_waitcnt lgkmcnt(8)
    v_mfma_f32_32x32x16_bf16 v[48:63], v[220:223], v[224:227], v[48:63]
    v_mfma_f32_32x32x16_bf16 v[64:79], v[220:223], v[228:231], v[64:79]
    v_mfma_f32_32x32x16_bf16 v[96:111], v[220:223], v[16:19], v[96:111]
    s_add_u32 s66, s60, 2
    s_add_u32 s61, s63, 2
    s_and_b32 s61, s61, 3
    s_mul_i32 s61, s61, 18432
    s_lshl_b32 s74, s66, 7
    s_cmp_lt_u32 s66, 10
    s_cselect_b32 s74, s74, 0x40000000
    s_mul_i32 s75, s66, 81920
    s_add_u32 s76, s61, s77
    s_cmp_lt_u32 s4, 2
    s_cselect_b32 s98, s61, 0
    s_cselect_b32 s99, s75, 0x40000000
    ds_read_b64_tr_b16 v[208:209], v12 offset:5120
    ds_read_b64_tr_b16 v[210:211], v12 offset:5760
    ds_read_b128 v[212:215], v8 offset:4096
    ds_read_b128 v[216:219], v10 offset:4096
    s_waitcnt lgkmcnt(8)
    v_mfma_f32_32x32x16_bf16 v[48:63], v[20:23], v[24:27], v[48:63]
    s_mov_b32 m0, s76
    s_add_u32 s64, s74, 64
    buffer_load_dwordx4 v4, s[40:43], s74 offen lds
    v_mfma_f32_32x32x16_bf16 v[64:79], v[20:23], v[28:31], v[64:79]
    s_add_u32 m0, s76, 4096
    s_nop 0
    buffer_load_dwordx4 v4, s[40:43], s64 offen lds
    v_mfma_f32_32x32x16_bf16 v[96:111], v[20:23], v[16:19], v[96:111]
    ds_read_b64_tr_b16 v[220:221], v12 offset:7680
    ds_read_b64_tr_b16 v[222:223], v12 offset:8320
    ds_read_b128 v[224:227], v9 offset:4096
    ds_read_b128 v[228:231], v11 offset:4096
    s_waitcnt lgkmcnt(8)
    v_mfma_f32_32x32x16_bf16 v[48:63], v[32:35], v[36:39], v[48:63]
    s_add_u32 m0, s61, s71
    s_nop 0
    buffer_load_dwordx4 v5, s[44:47], s75 offen lds
    v_mfma_f32_32x32x16_bf16 v[64:79], v[32:35], v[40:43], v[64:79]
    s_add_u32 m0, s61, s72
    s_nop 0
    buffer_load_dwordx4 v6, s[44:47], s75 offen lds
    v_mfma_f32_32x32x16_bf16 v[96:111], v[32:35], v[16:19], v[96:111]
    s_add_u32 m0, s98, s73
    s_nop 0
    buffer_load_dwordx4 v7, s[44:47], s99 offen lds
    s_waitcnt vmcnt(5)
    s_barrier
    s_cmp_eq_u32 s63, 3
    s_mov_b32 s62, 18432
    s_cselect_b32 s62, -55296, s62
    v_add_u32 v8, s62, v8
    v_add_u32 v9, s62, v9
    v_add_u32 v10, s62, v10
    v_add_u32 v11, s62, v11
    v_add_u32 v12, s62, v12
    s_add_u32 s63, s63, 1
    s_and_b32 s63, s63, 3
    s_add_u32 s60, s60, 1
    ds_read_b64_tr_b16 v[20:21], v12 offset:0
    ds_read_b64_tr_b16 v[22:23], v12 offset:640
    ds_read_b128 v[24:27], v8 offset:0
    ds_read_b128 v[28:31], v10 offset:0
    s_waitcnt lgkmcnt(8)
    v_mfma_f32_32x32x16_bf16 v[48:63], v[208:211], v[212:215], v[48:63]
    v_mfma_f32_32x32x16_bf16 v[64:79], v[208:211], v[216:219], v[64:79]
    v_mfma_f32_32x32x16_bf16 v[96:111], v[208:211], v[16:19], v[96:111]
    ds_read_b64_tr_b16 v[32:33], v12 offset:2560
    ds_read_b64_tr_b16 v[34:35], v12 offset:3200
    ds_read_b128 v[36:39], v9 offset:0
    ds_read_b128 v[40:43], v11 offset:0
    s_waitcnt lgkmcnt(8)
    v_mfma_f32_32x32x16_bf16 v[48:63], v[220:223], v[224:227], v[48:63]
    v_mfma_f32_32x32x16_bf16 v[64:79], v[220:223], v[228:231], v[64:79]
    v_mfma_f32_32x32x16_bf16 v[96:111], v[220:223], v[16:19], v[96:111]
    ds_read_b64_tr_b16 v[208:209], v12 offset:5120
    ds_read_b64_tr_b16 v[210:211], v12 offset:5760
    ds_read_b128 v[212:215], v8 offset:4096
    ds_read_b128 v[216:219], v10 offset:4096
    s_waitcnt lgkmcnt(8)
    v_mfma_f32_32x32x16_bf16 v[48:63], v[20:23], v[24:27], v[48:63]
    v_mfma_f32_32x32x16_bf16 v[64:79], v[20:23], v[28:31], v[64:79]
    v_mfma_f32_32x32x16_bf16 v[96:111], v[20:23], v[16:19], v[96:111]
    ds_read_b64_tr_b16 v[220:221], v12 offset:7680
    ds_read_b64_tr_b16 v[222:223], v12 offset:8320
    ds_read_b128 v[224:227], v9 offset:4096
    ds_read_b128 v[228:231], v11 offset:4096
    s_waitcnt lgkmcnt(8)
    v_mfma_f32_32x32x16_bf16 v[48:63], v[32:35], v[36:39], v[48:63]
    v_mfma_f32_32x32x16_bf16 v[64:79], v[32:35], v[40:43], v[64:79]
    v_mfma_f32_32x32x16_bf16 v[96:111], v[32:35], v[16:19], v[96:111]
    s_waitcnt vmcnt(0)
    s_barrier
    s_cmp_eq_u32 s63, 3
    s_mov_b32 s62, 18432
    s_cselect_b32 s62, -55296, s62
    v_add_u32 v8, s62, v8
    v_add_u32 v9, s62, v9
    v_add_u32 v10, s62, v10
    v_add_u32 v11, s62, v11
    v_add_u32 v12, s62, v12
    s_add_u32 s63, s63, 1
    s_and_b32 s63, s63, 3
    s_add_u32 s60, s60, 1
    ds_read_b64_tr_b16 v[20:21], v12 offset:0
    ds_read_b64_tr_b16 v[22:23], v12 offset:640
    ds_read_b128 v[24:27], v8 offset:0
    ds_read_b128 v[28:31], v10 offset:0
    s_waitcnt lgkmcnt(8)
    v_mfma_f32_32x32x16_bf16 v[48:63], v[208:211], v[212:215], v[48:63]
    v_mfma_f32_32x32x16_bf16 v[64:79], v[208:211], v[216:219], v[64:79]
    v_mfma_f32_32x32x16_bf16 v[96:111], v[208:211], v[16:19], v[96:111]
    ds_read_b64_tr_b16 v[32:33], v12 offset:2560
    ds_read_b64_tr_b16 v[34:35], v12 offset:3200
    ds_read_b128 v[36:39], v9 offset:0
    ds_read_b128 v[40:43], v11 offset:0
    s_waitcnt lgkmcnt(8)
    v_mfma_f32_32x32x16_bf16 v[48:63], v[220:223], v[224:227], v[48:63]
    v_mfma_f32_32x32x16_bf16 v[64:79], v[220:223], v[228:231], v[64:79]
    v_mfma_f32_32x32x16_bf16 v[96:111], v[220:223], v[16:19], v[96:111]
    ds_read_b64_tr_b16 v[208:209], v12 offset:5120
    ds_read_b64_tr_b16 v[210:211], v12 offset:5760
    ds_read_b128 v[212:215], v8 offset:4096
    ds_read_b128 v[216:219], v10 offset:4096
    s_waitcnt lgkmcnt(8)
    v_mfma_f32_32x32x16_bf16 v[48:63], v[20:23], v[24:27], v[48:63]
    v_mfma_f32_32x32x16_bf16 v[64:79], v[20:23], v[28:31], v[64:79]
    v_mfma_f32_32x32x16_bf16 v[96:111], v[20:23], v[16:19], v[96:111]
    ds_read_b64_tr_b16 v[220:221], v12 offset:7680
    ds_read_b64_tr_b16 v[222:223], v12 offset:8320
    ds_read_b128 v[224:227], v9 offset:4096
    ds_read_b128 v[228:231], v11 offset:4096
    s_waitcnt lgkmcnt(8)
    v_mfma_f32_32x32x16_bf16 v[48:63], v[32:35], v[36:39], v[48:63]
    v_mfma_f32_32x32x16_bf16 v[64:79], v[32:35], v[40:43], v[64:79]
    v_mfma_f32_32x32x16_bf16 v[96:111], v[32:35], v[16:19], v[96:111]
    s_waitcnt lgkmcnt(4)
    v_mfma_f32_32x32x16_bf16 v[48:63], v[208:211], v[212:215], v[48:63]
    v_mfma_f32_32x32x16_bf16 v[64:79], v[208:211], v[216:219], v[64:79]
    v_mfma_f32_32x32x16_bf16 v[96:111], v[208:211], v[16:19], v[96:111]
    s_waitcnt lgkmcnt(0)
    v_mfma_f32_32x32x16_bf16 v[48:63], v[220:223], v[224:227], v[48:63]
    v_mfma_f32_32x32x16_bf16 v[64:79], v[220:223], v[228:231], v[64:79]
    v_mfma_f32_32x32x16_bf16 v[96:111], v[220:223], v[16:19], v[96:111]
    s_barrier
    s_mov_b32 s56, s30
    s_mov_b32 s57, s31
    s_mov_b32 s58, 0x100
    s_mov_b32 s59, 0x20000
    v_mov_b32 v254, 0
    buffer_load_dword v254, v254, s[56:59], 0 offen sc1
    s_waitcnt vmcnt(0)
    s_mov_b32 s100, 0
INIT_6:
    v_cmp_eq_u32 vcc, 0, v254
    s_nop 1
    s_cmp_eq_u64 vcc, 0
    s_cbranch_scc1 INITE_7
    s_sleep 2
    s_mov_b32 s56, s30
    s_mov_b32 s57, s31
    s_mov_b32 s58, 0x100
    s_mov_b32 s59, 0x20000
    v_mov_b32 v254, 0
    buffer_load_dword v254, v254, s[56:59], 0 offen sc1
    s_waitcnt vmcnt(0)
    s_add_u32 s100, s100, 1
    s_cmp_lt_u32 s100, 65536
    s_cbranch_scc1 INIT_6
INITE_7:
    s_add_u32 s56, s32, 0xa00
    s_addc_u32 s57, s33, 0
    s_mov_b32 s58, 0x8000
    s_mov_b32 s59, 0x20000
    v_and_b32 v20, 63, v0
    v_lshlrev_b32 v20, 7, v20
    s_mov_b32 s100, 0
POLL_8:
    buffer_load_dword v21, v20, s[56:59], 0 offen sc1
    s_waitcnt vmcnt(0)
    v_cmp_ne_u32 vcc, 4, v21
    s_nop 1
    s_cmp_eq_u64 vcc, 0
    s_cbranch_scc1 POLLE_9
    s_sleep 4
    s_add_u32 s100, s100, 1
    s_cmp_lt_u32 s100, 65536
    s_cbranch_scc1 POLL_8
POLLE_9:
    s_add_u32 s52, s32, 0xc000
    s_addc_u32 s53, s33, 0
    s_mov_b32 s54, 0x4000
    s_mov_b32 s55, 0x20000
    v_lshlrev_b32 v46, 3, v3
    s_lshl_b32 s64, s38, 8
    s_lshl_b32 s65, s39, 8
    buffer_load_dwordx2 v[14:15], v46, s[52:55], s64 offen sc1
    buffer_load_dwordx2 v[44:45], v46, s[52:55], s65 offen sc1
    s_mov_b32 s68, 36864
    s_mov_b32 s69, 0
    s_mul_i32 s64, s4, 6144
    s_add_u32 m0, s68, s64
    s_add_u32 s65, s69, 4096
    buffer_load_dwordx4 v246, s[48:51], s69 offen sc1 lds
    buffer_load_dwordx4 v246, s[48:51], s69 offen offset:1024 sc1 lds
    buffer_load_dwordx4 v246, s[48:51], s69 offen offset:2048 sc1 lds
    buffer_load_dwordx4 v246, s[48:51], s69 offen offset:3072 sc1 lds
    s_add_u32 m0, m0, 4096
    s_nop 0
    buffer_load_dwordx4 v246, s[48:51], s65 offen sc1 lds
    buffer_load_dwordx4 v246, s[48:51], s65 offen offset:1024 sc1 lds
A_kvdone_5:
    s_mov_b32 s68, 4096
    s_mov_b32 s69, 22528
    s_mul_i32 s64, s4, 6144
    s_add_u32 m0, s68, s64
    s_add_u32 s65, s69, 4096
    buffer_load_dwordx4 v246, s[48:51], s69 offen sc1 lds
    buffer_load_dwordx4 v246, s[48:51], s69 offen offset:1024 sc1 lds
    buffer_load_dwordx4 v246, s[48:51], s69 offen offset:2048 sc1 lds
    buffer_load_dwordx4 v246, s[48:51], s69 offen offset:3072 sc1 lds
    s_add_u32 m0, m0, 4096
    s_nop 0
    buffer_load_dwordx4 v246, s[48:51], s65 offen sc1 lds
    buffer_load_dwordx4 v246, s[48:51], s65 offen offset:1024 sc1 lds
    s_mov_b32 s68, 36864
    s_mov_b32 s69, 45056
    s_waitcnt vmcnt(12)
    v_mul_f32 v15, 0x3ea52b5c, v15
    v_mul_f32 v45, 0x3ea52b5c, v45
    v_fma_f32 v48, -v14, v96, v48
    v_fma_f32 v49, -v14, v97, v49
    v_fma_f32 v50, -v14, v98, v50
    v_fma_f32 v51, -v14, v99, v51
    v_fma_f32 v52, -v14, v100, v52
    v_fma_f32 v53, -v14, v101, v53
    v_fma_f32 v54, -v14, v102, v54
    v_fma_f32 v55, -v14, v103, v55
    v_fma_f32 v56, -v14, v104, v56
    v_fma_f32 v57, -v14, v105, v57
    v_fma_f32 v58, -v14, v106, v58
    v_fma_f32 v59, -v14, v107, v59
    v_mul_f32 v48, v15, v48
    v_mul_f32 v49, v15, v49
    v_mul_f32 v50, v15, v50
    v_mul_f32 v51, v15, v51
    v_mul_f32 v52, v15, v52
    v_mul_f32 v53, v15, v53
    v_mul_f32 v54, v15, v54
    v_mul_f32 v55, v15, v55
    v_mul_f32 v56, v15, v56
    v_mul_f32 v57, v15, v57
    v_mul_f32 v58, v15, v58
    v_mul_f32 v59, v15, v59
    v_cvt_pk_bf16_f32 v80, v48, v49
    v_cvt_pk_bf16_f32 v81, v50, v51
    v_cvt_pk_bf16_f32 v82, v52, v53
    v_cvt_pk_bf16_f32 v83, v54, v55
    v_cvt_pk_bf16_f32 v84, v56, v57
    v_cvt_pk_bf16_f32 v85, v58, v59
    v_fma_f32 v64, -v44, v96, v64
    v_fma_f32 v65, -v44, v97, v65
    v_fma_f32 v66, -v44, v98, v66
    v_fma_f32 v67, -v44, v99, v67
    v_fma_f32 v68, -v44, v100, v68
    v_fma_f32 v69, -v44, v101, v69
    v_fma_f32 v70, -v44, v102, v70
    v_fma_f32 v71, -v44, v103, v71
    v_fma_f32 v72, -v44, v104, v72
    v_fma_f32 v73, -v44, v105, v73
    v_fma_f32 v74, -v44, v106, v74
    v_fma_f32 v75, -v44, v107, v75
    v_mul_f32 v64, v45, v64
    v_mul_f32 v65, v45, v65
    v_mul_f32 v66, v45, v66
    v_mul_f32 v67, v45, v67
    v_mul_f32 v68, v45, v68
    v_mul_f32 v69, v45, v69
    v_mul_f32 v70, v45, v70
    v_mul_f32 v71, v45, v71
    v_mul_f32 v72, v45, v72
    v_mul_f32 v73, v45, v73
    v_mul_f32 v74, v45, v74
    v_mul_f32 v75, v45, v75
    v_cvt_pk_bf16_f32 v88, v64, v65
    v_cvt_pk_bf16_f32 v89, v66, v67
    v_cvt_pk_bf16_f32 v90, v68, v69
    v_cvt_pk_bf16_f32 v91, v70, v71
    v_cvt_pk_bf16_f32 v86, v72, v73
    v_cvt_pk_bf16_f32 v87, v74, v75
    v_cmp_gt_u32 vcc, 32, v1
    s_nop 1
    v_cndmask_b32 v84, 0, v84, vcc
    v_cndmask_b32 v85, 0, v85, vcc
    v_cndmask_b32 v86, 0, v86, vcc
    v_cndmask_b32 v87, 0, v87, vcc
    s_mov_b32 s70, 0
    s_setprio 1
AT_pass_10:
    s_waitcnt vmcnt(6)
    s_barrier
    ds_read_b128 v[208:211], v240
    ds_read2_b64 v[216:219], v242 offset0:0 offset1:32
    ds_read_b128 v[224:227], v244
    ds_read_b128 v[232:235], v244 offset:768
    s_waitcnt lgkmcnt(2)
    v_mfma_f32_32x32x16_bf16 v[96:111], v[208:211], v[80:83], v[160:175]
    v_mfma_f32_32x32x8bf16_1k v[96:111], v[216:217], v[84:85], v[96:111]
    s_mov_b32 s67, 0
    s_waitcnt lgkmcnt(0)
    s_nop 15
AT_loop_11:
    v_mfma_f32_32x32x16_bf16 v[112:127], v[208:211], v[88:91], v[176:191]
    ds_read_b128 v[212:215], v240 offset:1024
    v_exp_f32 v192, v96
    v_exp_f32 v193, v97
    v_cvt_pk_bf16_f32 v206, v196, v197
    v_cvt_pk_bf16_f32 v207, v198, v199
    v_exp_f32 v194, v98
    v_exp_f32 v195, v99
    v_mfma_f32_32x32x16_bf16 v[144:159], v[236:239], v[204:207], v[144:159]
    v_exp_f32 v196, v100
    v_exp_f32 v197, v101
    v_cvt_pk_bf16_f32 v200, v192, v193
    v_cvt_pk_bf16_f32 v201, v194, v195
    v_exp_f32 v198, v102
    v_exp_f32 v199, v103
    v_mfma_f32_32x32x8bf16_1k v[112:127], v[216:217], v[86:87], v[112:127]
    ds_read_b128 v[228:231], v244 offset:1536
    v_exp_f32 v192, v104
    v_exp_f32 v193, v105
    v_cvt_pk_bf16_f32 v202, v196, v197
    v_cvt_pk_bf16_f32 v203, v198, v199
    v_exp_f32 v194, v106
    v_exp_f32 v195, v107
    v_mfma_f32_32x32x16_bf16 v[128:143], v[224:227], v[200:203], v[128:143]
    s_waitcnt lgkmcnt(1)
    v_exp_f32 v196, v108
    v_exp_f32 v197, v109
    v_cvt_pk_bf16_f32 v204, v192, v193
    v_cvt_pk_bf16_f32 v205, v194, v195
    v_exp_f32 v198, v110
    v_exp_f32 v199, v111
    v_mfma_f32_32x32x16_bf16 v[96:111], v[212:215], v[80:83], v[160:175]
    ds_read_b128 v[236:239], v244 offset:2304
    v_exp_f32 v192, v112
    v_exp_f32 v193, v113
    v_cvt_pk_bf16_f32 v206, v196, v197
    v_cvt_pk_bf16_f32 v207, v198, v199
    v_exp_f32 v194, v114
    v_exp_f32 v195, v115
    v_mfma_f32_32x32x16_bf16 v[128:143], v[232:235], v[204:207], v[128:143]
    v_exp_f32 v196, v116
    v_exp_f32 v197, v117
    v_cvt_pk_bf16_f32 v200, v192, v193
    v_cvt_pk_bf16_f32 v201, v194, v195
    v_exp_f32 v198, v118
    v_exp_f32 v199, v119
    v_mfma_f32_32x32x8bf16_1k v[96:111], v[218:219], v[84:85], v[96:111]
    ds_read2_b64 v[220:223], v242 offset0:64 offset1:96
    v_exp_f32 v192, v120
    v_exp_f32 v193, v121
    v_cvt_pk_bf16_f32 v202, v196, v197
    v_cvt_pk_bf16_f32 v203, v198, v199
    v_exp_f32 v194, v122
    v_exp_f32 v195, v123
    v_mfma_f32_32x32x16_bf16 v[144:159], v[224:227], v[200:203], v[144:159]
    s_waitcnt lgkmcnt(1)
    v_exp_f32 v196, v124
    v_exp_f32 v197, v125
    v_cvt_pk_bf16_f32 v204, v192, v193
    v_cvt_pk_bf16_f32 v205, v194, v195
    v_exp_f32 v198, v126
    v_exp_f32 v199, v127
    v_mfma_f32_32x32x16_bf16 v[112:127], v[212:215], v[88:91], v[176:191]
    ds_read_b128 v[208:211], v240 offset:2048
    v_exp_f32 v192, v96
    v_exp_f32 v193, v97
    v_cvt_pk_bf16_f32 v206, v196, v197
    v_cvt_pk_bf16_f32 v207, v198, v199
    v_exp_f32 v194, v98
    v_exp_f32 v195, v99
    v_mfma_f32_32x32x16_bf16 v[144:159], v[232:235], v[204:207], v[144:159]
    v_exp_f32 v196, v100
    v_exp_f32 v197, v101
    v_cvt_pk_bf16_f32 v200, v192, v193
    v_cvt_pk_bf16_f32 v201, v194, v195
    v_exp_f32 v198, v102
    v_exp_f32 v199, v103
    v_mfma_f32_32x32x8bf16_1k v[112:127], v[218:219], v[86:87], v[112:127]
    ds_read_b128 v[224:227], v244 offset:3072
    v_exp_f32 v192, v104
    v_exp_f32 v193, v105
    v_cvt_pk_bf16_f32 v202, v196, v197
    v_cvt_pk_bf16_f32 v203, v198, v199
    v_exp_f32 v194, v106
    v_exp_f32 v195, v107
    v_mfma_f32_32x32x16_bf16 v[128:143], v[228:231], v[200:203], v[128:143]
    s_waitcnt lgkmcnt(1)
    v_exp_f32 v196, v108
    v_exp_f32 v197, v109
    v_cvt_pk_bf16_f32 v204, v192, v193
    v_cvt_pk_bf16_f32 v205, v194, v195
    v_exp_f32 v198, v110
    v_exp_f32 v199, v111
    v_mfma_f32_32x32x16_bf16 v[96:111], v[208:211], v[80:83], v[160:175]
    ds_read_b128 v[232:235], v244 offset:3840
    v_exp_f32 v192, v112
    v_exp_f32 v193, v113
    v_cvt_pk_bf16_f32 v206, v196, v197
    v_cvt_pk_bf16_f32 v207, v198, v199
    v_exp_f32 v194, v114
    v_exp_f32 v195, v115
    v_mfma_f32_32x32x16_bf16 v[128:143], v[236:239], v[204:207], v[128:143]
    v_exp_f32 v196, v116
    v_exp_f32 v197, v117
    v_cvt_pk_bf16_f32 v200, v192, v193
    v_cvt_pk_bf16_f32 v201, v194, v195
    v_exp_f32 v198, v118
    v_exp_f32 v199, v119
    v_mfma_f32_32x32x8bf16_1k v[96:111], v[220:221], v[84:85], v[96:111]
    v_exp_f32 v192, v120
    v_exp_f32 v193, v121
    v_cvt_pk_bf16_f32 v202, v196, v197
    v_cvt_pk_bf16_f32 v203, v198, v199
    v_exp_f32 v194, v122
    v_exp_f32 v195, v123
    v_mfma_f32_32x32x16_bf16 v[144:159], v[228:231], v[200:203], v[144:159]
    s_waitcnt lgkmcnt(1)
    v_exp_f32 v196, v124
    v_exp_f32 v197, v125
    v_cvt_pk_bf16_f32 v204, v192, v193
    v_cvt_pk_bf16_f32 v205, v194, v195
    v_exp_f32 v198, v126
    v_exp_f32 v199, v127
    v_mfma_f32_32x32x16_bf16 v[112:127], v[208:211], v[88:91], v[176:191]
    ds_read_b128 v[212:215], v240 offset:3072
    v_exp_f32 v192, v96
    v_exp_f32 v193, v97
    v_cvt_pk_bf16_f32 v206, v196, v197
    v_cvt_pk_bf16_f32 v207, v198, v199
    v_exp_f32 v194, v98
    v_exp_f32 v195, v99
    v_mfma_f32_32x32x16_bf16 v[144:159], v[236:239], v[204:207], v[144:159]
    v_exp_f32 v196, v100
    v_exp_f32 v197, v101
    v_cvt_pk_bf16_f32 v200, v192, v193
    v_cvt_pk_bf16_f32 v201, v194, v195
    v_exp_f32 v198, v102
    v_exp_f32 v199, v103
    v_mfma_f32_32x32x8bf16_1k v[112:127], v[220:221], v[86:87], v[112:127]
    ds_read_b128 v[228:231], v244 offset:4608
    v_exp_f32 v192, v104
    v_exp_f32 v193, v105
    v_cvt_pk_bf16_f32 v202, v196, v197
    v_cvt_pk_bf16_f32 v203, v198, v199
    v_exp_f32 v194, v106
    v_exp_f32 v195, v107
    v_mfma_f32_32x32x16_bf16 v[128:143], v[224:227], v[200:203], v[128:143]
    s_waitcnt lgkmcnt(1)
    v_exp_f32 v196, v108
    v_exp_f32 v197, v109
    v_cvt_pk_bf16_f32 v204, v192, v193
    v_cvt_pk_bf16_f32 v205, v194, v195
    v_exp_f32 v198, v110
    v_exp_f32 v199, v111
    v_mfma_f32_32x32x16_bf16 v[96:111], v[212:215], v[80:83], v[160:175]
    ds_read_b128 v[236:239], v244 offset:5376
    v_exp_f32 v192, v112
    v_exp_f32 v193, v113
    v_cvt_pk_bf16_f32 v206, v196, v197
    v_cvt_pk_bf16_f32 v207, v198, v199
    v_exp_f32 v194, v114
    v_exp_f32 v195, v115
    v_mfma_f32_32x32x16_bf16 v[128:143], v[232:235], v[204:207], v[128:143]
    v_exp_f32 v196, v116
    v_exp_f32 v197, v117
    v_cvt_pk_bf16_f32 v200, v192, v193
    v_cvt_pk_bf16_f32 v201, v194, v195
    v_exp_f32 v198, v118
    v_exp_f32 v199, v119
    v_mfma_f32_32x32x8bf16_1k v[96:111], v[222:223], v[84:85], v[96:111]
    ds_read2_b64 v[216:219], v242 offset0:128 offset1:160
    v_exp_f32 v192, v120
    v_exp_f32 v193, v121
    v_cvt_pk_bf16_f32 v202, v196, v197
    v_cvt_pk_bf16_f32 v203, v198, v199
    v_exp_f32 v194, v122
    v_exp_f32 v195, v123
    v_mfma_f32_32x32x16_bf16 v[144:159], v[224:227], v[200:203], v[144:159]
    s_waitcnt lgkmcnt(1)
    v_exp_f32 v196, v124
    v_exp_f32 v197, v125
    v_cvt_pk_bf16_f32 v204, v192, v193
    v_cvt_pk_bf16_f32 v205, v194, v195
    v_exp_f32 v198, v126
    v_exp_f32 v199, v127
    v_mfma_f32_32x32x16_bf16 v[112:127], v[212:215], v[88:91], v[176:191]
    ds_read_b128 v[208:211], v240 offset:4096
    v_exp_f32 v192, v96
    v_exp_f32 v193, v97
    v_cvt_pk_bf16_f32 v206, v196, v197
    v_cvt_pk_bf16_f32 v207, v198, v199
    v_exp_f32 v194, v98
    v_exp_f32 v195, v99
    v_mfma_f32_32x32x16_bf16 v[144:159], v[232:235], v[204:207], v[144:159]
    v_exp_f32 v196, v100
    v_exp_f32 v197, v101
    v_cvt_pk_bf16_f32 v200, v192, v193
    v_cvt_pk_bf16_f32 v201, v194, v195
    v_exp_f32 v198, v102
    v_exp_f32 v199, v103
    v_mfma_f32_32x32x8bf16_1k v[112:127], v[222:223], v[86:87], v[112:127]
    ds_read_b128 v[224:227], v244 offset:6144
    v_exp_f32 v192, v104
    v_exp_f32 v193, v105
    v_cvt_pk_bf16_f32 v202, v196, v197
    v_cvt_pk_bf16_f32 v203, v198, v199
    v_exp_f32 v194, v106
    v_exp_f32 v195, v107
    v_mfma_f32_32x32x16_bf16 v[128:143], v[228:231], v[200:203], v[128:143]
    s_waitcnt lgkmcnt(1)
    v_exp_f32 v196, v108
    v_exp_f32 v197, v109
    v_cvt_pk_bf16_f32 v204, v192, v193
    v_cvt_pk_bf16_f32 v205, v194, v195
    v_exp_f32 v198, v110
    v_exp_f32 v199, v111
    v_mfma_f32_32x32x16_bf16 v[96:111], v[208:211], v[80:83], v[160:175]
    ds_read_b128 v[232:235], v244 offset:6912
    v_exp_f32 v192, v112
    v_exp_f32 v193, v113
    v_cvt_pk_bf16_f32 v206, v196, v197
    v_cvt_pk_bf16_f32 v207, v198, v199
    v_exp_f32 v194, v114
    v_exp_f32 v195, v115
    v_mfma_f32_32x32x16_bf16 v[128:143], v[236:239], v[204:207], v[128:143]
    v_exp_f32 v196, v116
    v_exp_f32 v197, v117
    v_cvt_pk_bf16_f32 v200, v192, v193
    v_cvt_pk_bf16_f32 v201, v194, v195
    v_exp_f32 v198, v118
    v_exp_f32 v199, v119
    v_mfma_f32_32x32x8bf16_1k v[96:111], v[216:217], v[84:85], v[96:111]
    v_exp_f32 v192, v120
    v_exp_f32 v193, v121
    v_cvt_pk_bf16_f32 v202, v196, v197
    v_cvt_pk_bf16_f32 v203, v198, v199
    v_exp_f32 v194, v122
    v_exp_f32 v195, v123
    v_mfma_f32_32x32x16_bf16 v[144:159], v[228:231], v[200:203], v[144:159]
    s_waitcnt lgkmcnt(1)
    v_exp_f32 v196, v124
    v_exp_f32 v197, v125
    v_cvt_pk_bf16_f32 v204, v192, v193
    v_cvt_pk_bf16_f32 v205, v194, v195
    v_exp_f32 v198, v126
    v_exp_f32 v199, v127
    v_mfma_f32_32x32x16_bf16 v[112:127], v[208:211], v[88:91], v[176:191]
    ds_read_b128 v[212:215], v240 offset:5120
    v_exp_f32 v192, v96
    v_exp_f32 v193, v97
    v_cvt_pk_bf16_f32 v206, v196, v197
    v_cvt_pk_bf16_f32 v207, v198, v199
    v_exp_f32 v194, v98
    v_exp_f32 v195, v99
    v_mfma_f32_32x32x16_bf16 v[144:159], v[236:239], v[204:207], v[144:159]
    v_exp_f32 v196, v100
    v_exp_f32 v197, v101
    v_cvt_pk_bf16_f32 v200, v192, v193
    v_cvt_pk_bf16_f32 v201, v194, v195
    v_exp_f32 v198, v102
    v_exp_f32 v199, v103
    v_mfma_f32_32x32x8bf16_1k v[112:127], v[216:217], v[86:87], v[112:127]
    ds_read_b128 v[228:231], v244 offset:7680
    v_exp_f32 v192, v104
    v_exp_f32 v193, v105
    v_cvt_pk_bf16_f32 v202, v196, v197
    v_cvt_pk_bf16_f32 v203, v198, v199
    v_exp_f32 v194, v106
    v_exp_f32 v195, v107
    v_mfma_f32_32x32x16_bf16 v[128:143], v[224:227], v[200:203], v[128:143]
    s_waitcnt lgkmcnt(1)
    v_exp_f32 v196, v108
    v_exp_f32 v197, v109
    v_cvt_pk_bf16_f32 v204, v192, v193
    v_cvt_pk_bf16_f32 v205, v194, v195
    v_exp_f32 v198, v110
    v_exp_f32 v199, v111
    v_mfma_f32_32x32x16_bf16 v[96:111], v[212:215], v[80:83], v[160:175]
    ds_read_b128 v[236:239], v244 offset:8448
    v_exp_f32 v192, v112
    v_exp_f32 v193, v113
    v_cvt_pk_bf16_f32 v206, v196, v197
    v_cvt_pk_bf16_f32 v207, v198, v199
    v_exp_f32 v194, v114
    v_exp_f32 v195, v115
    v_mfma_f32_32x32x16_bf16 v[128:143], v[232:235], v[204:207], v[128:143]
    v_exp_f32 v196, v116
    v_exp_f32 v197, v117
    v_cvt_pk_bf16_f32 v200, v192, v193
    v_cvt_pk_bf16_f32 v201, v194, v195
    v_exp_f32 v198, v118
    v_exp_f32 v199, v119
    v_mfma_f32_32x32x8bf16_1k v[96:111], v[218:219], v[84:85], v[96:111]
    ds_read2_b64 v[220:223], v242 offset0:192 offset1:224
    v_exp_f32 v192, v120
    v_exp_f32 v193, v121
    v_cvt_pk_bf16_f32 v202, v196, v197
    v_cvt_pk_bf16_f32 v203, v198, v199
    v_exp_f32 v194, v122
    v_exp_f32 v195, v123
    v_mfma_f32_32x32x16_bf16 v[144:159], v[224:227], v[200:203], v[144:159]
    s_waitcnt lgkmcnt(1)
    v_exp_f32 v196, v124
    v_exp_f32 v197, v125
    v_cvt_pk_bf16_f32 v204, v192, v193
    v_cvt_pk_bf16_f32 v205, v194, v195
    v_exp_f32 v198, v126
    v_exp_f32 v199, v127
    v_mfma_f32_32x32x16_bf16 v[112:127], v[212:215], v[88:91], v[176:191]
    ds_read_b128 v[208:211], v240 offset:6144
    v_exp_f32 v192, v96
    v_exp_f32 v193, v97
    v_cvt_pk_bf16_f32 v206, v196, v197
    v_cvt_pk_bf16_f32 v207, v198, v199
    v_exp_f32 v194, v98
    v_exp_f32 v195, v99
    v_mfma_f32_32x32x16_bf16 v[144:159], v[232:235], v[204:207], v[144:159]
    v_exp_f32 v196, v100
    v_exp_f32 v197, v101
    v_cvt_pk_bf16_f32 v200, v192, v193
    v_cvt_pk_bf16_f32 v201, v194, v195
    v_exp_f32 v198, v102
    v_exp_f32 v199, v103
    v_mfma_f32_32x32x8bf16_1k v[112:127], v[218:219], v[86:87], v[112:127]
    ds_read_b128 v[224:227], v244 offset:9216
    v_exp_f32 v192, v104
    v_exp_f32 v193, v105
    v_cvt_pk_bf16_f32 v202, v196, v197
    v_cvt_pk_bf16_f32 v203, v198, v199
    v_exp_f32 v194, v106
    v_exp_f32 v195, v107
    v_mfma_f32_32x32x16_bf16 v[128:143], v[228:231], v[200:203], v[128:143]
    s_waitcnt lgkmcnt(1)
    v_exp_f32 v196, v108
    v_exp_f32 v197, v109
    v_cvt_pk_bf16_f32 v204, v192, v193
    v_cvt_pk_bf16_f32 v205, v194, v195
    v_exp_f32 v198, v110
    v_exp_f32 v199, v111
    v_mfma_f32_32x32x16_bf16 v[96:111], v[208:211], v[80:83], v[160:175]
    ds_read_b128 v[232:235], v244 offset:9984
    v_exp_f32 v192, v112
    v_exp_f32 v193, v113
    v_cvt_pk_bf16_f32 v206, v196, v197
    v_cvt_pk_bf16_f32 v207, v198, v199
    v_exp_f32 v194, v114
    v_exp_f32 v195, v115
    v_mfma_f32_32x32x16_bf16 v[128:143], v[236:239], v[204:207], v[128:143]
    v_exp_f32 v196, v116
    v_exp_f32 v197, v117
    v_cvt_pk_bf16_f32 v200, v192, v193
    v_cvt_pk_bf16_f32 v201, v194, v195
    v_exp_f32 v198, v118
    v_exp_f32 v199, v119
    v_mfma_f32_32x32x8bf16_1k v[96:111], v[220:221], v[84:85], v[96:111]
    v_exp_f32 v192, v120
    v_exp_f32 v193, v121
    v_cvt_pk_bf16_f32 v202, v196, v197
    v_cvt_pk_bf16_f32 v203, v198, v199
    v_exp_f32 v194, v122
    v_exp_f32 v195, v123
    v_mfma_f32_32x32x16_bf16 v[144:159], v[228:231], v[200:203], v[144:159]
    s_waitcnt lgkmcnt(1)
    v_exp_f32 v196, v124
    v_exp_f32 v197, v125
    v_cvt_pk_bf16_f32 v204, v192, v193
    v_cvt_pk_bf16_f32 v205, v194, v195
    v_exp_f32 v198, v126
    v_exp_f32 v199, v127
    v_mfma_f32_32x32x16_bf16 v[112:127], v[208:211], v[88:91], v[176:191]
    ds_read_b128 v[212:215], v240 offset:7168
    v_exp_f32 v192, v96
    v_exp_f32 v193, v97
    v_cvt_pk_bf16_f32 v206, v196, v197
    v_cvt_pk_bf16_f32 v207, v198, v199
    v_exp_f32 v194, v98
    v_exp_f32 v195, v99
    v_mfma_f32_32x32x16_bf16 v[144:159], v[236:239], v[204:207], v[144:159]
    v_exp_f32 v196, v100
    v_exp_f32 v197, v101
    v_cvt_pk_bf16_f32 v200, v192, v193
    v_cvt_pk_bf16_f32 v201, v194, v195
    v_exp_f32 v198, v102
    v_exp_f32 v199, v103
    v_mfma_f32_32x32x8bf16_1k v[112:127], v[220:221], v[86:87], v[112:127]
    ds_read_b128 v[228:231], v244 offset:10752
    v_exp_f32 v192, v104
    v_exp_f32 v193, v105
    v_cvt_pk_bf16_f32 v202, v196, v197
    v_cvt_pk_bf16_f32 v203, v198, v199
    v_exp_f32 v194, v106
    v_exp_f32 v195, v107
    v_mfma_f32_32x32x16_bf16 v[128:143], v[224:227], v[200:203], v[128:143]
    s_waitcnt lgkmcnt(1)
    v_exp_f32 v196, v108
    v_exp_f32 v197, v109
    v_cvt_pk_bf16_f32 v204, v192, v193
    v_cvt_pk_bf16_f32 v205, v194, v195
    v_exp_f32 v198, v110
    v_exp_f32 v199, v111
    v_mfma_f32_32x32x16_bf16 v[96:111], v[212:215], v[80:83], v[160:175]
    ds_read_b128 v[236:239], v244 offset:11520
    v_exp_f32 v192, v112
    v_exp_f32 v193, v113
    v_cvt_pk_bf16_f32 v206, v196, v197
    v_cvt_pk_bf16_f32 v207, v198, v199
    v_exp_f32 v194, v114
    v_exp_f32 v195, v115
    v_mfma_f32_32x32x16_bf16 v[128:143], v[232:235], v[204:207], v[128:143]
    v_exp_f32 v196, v116
    v_exp_f32 v197, v117
    v_cvt_pk_bf16_f32 v200, v192, v193
    v_cvt_pk_bf16_f32 v201, v194, v195
    v_exp_f32 v198, v118
    v_exp_f32 v199, v119
    v_mfma_f32_32x32x8bf16_1k v[96:111], v[222:223], v[84:85], v[96:111]
    v_exp_f32 v192, v120
    v_exp_f32 v193, v121
    v_cvt_pk_bf16_f32 v202, v196, v197
    v_cvt_pk_bf16_f32 v203, v198, v199
    v_exp_f32 v194, v122
    v_exp_f32 v195, v123
    v_mfma_f32_32x32x16_bf16 v[144:159], v[224:227], v[200:203], v[144:159]
    s_waitcnt vmcnt(0) lgkmcnt(0)
    s_barrier
    v_exp_f32 v196, v124
    v_exp_f32 v197, v125
    v_cvt_pk_bf16_f32 v204, v192, v193
    v_cvt_pk_bf16_f32 v205, v194, v195
    v_exp_f32 v198, v126
    v_exp_f32 v199, v127
    v_mfma_f32_32x32x16_bf16 v[112:127], v[212:215], v[88:91], v[176:191]
    ds_read_b128 v[208:211], v241 offset:0
    s_cmp_gt_u32 s67, 5
    s_cbranch_scc1 AT_sk_12
    s_mul_i32 s64, s4, 6144
    s_add_u32 m0, s68, s64
    s_add_u32 s65, s69, 4096
    buffer_load_dwordx4 v246, s[48:51], s69 offen sc1 lds
    buffer_load_dwordx4 v246, s[48:51], s69 offen offset:1024 sc1 lds
AT_sk_12:
    v_exp_f32 v192, v96
    v_exp_f32 v193, v97
    v_cvt_pk_bf16_f32 v206, v196, v197
    v_cvt_pk_bf16_f32 v207, v198, v199
    v_exp_f32 v194, v98
    v_exp_f32 v195, v99
    v_mfma_f32_32x32x16_bf16 v[144:159], v[232:235], v[204:207], v[144:159]
    ds_read2_b64 v[216:219], v243 offset0:0 offset1:32
    v_exp_f32 v196, v100
    v_exp_f32 v197, v101
    v_cvt_pk_bf16_f32 v200, v192, v193
    v_cvt_pk_bf16_f32 v201, v194, v195
    v_exp_f32 v198, v102
    v_exp_f32 v199, v103
    v_mfma_f32_32x32x8bf16_1k v[112:127], v[222:223], v[86:87], v[112:127]
    ds_read_b128 v[224:227], v245 offset:0
    v_exp_f32 v192, v104
    v_exp_f32 v193, v105
    v_cvt_pk_bf16_f32 v202, v196, v197
    v_cvt_pk_bf16_f32 v203, v198, v199
    v_exp_f32 v194, v106
    v_exp_f32 v195, v107
    v_mfma_f32_32x32x16_bf16 v[128:143], v[228:231], v[200:203], v[128:143]
    s_waitcnt lgkmcnt(1)
    s_cmp_gt_u32 s67, 5
    s_cbranch_scc1 AT_sk_13
    buffer_load_dwordx4 v246, s[48:51], s69 offen offset:2048 sc1 lds
    buffer_load_dwordx4 v246, s[48:51], s69 offen offset:3072 sc1 lds
AT_sk_13:
    v_exp_f32 v196, v108
    v_exp_f32 v197, v109
    v_cvt_pk_bf16_f32 v204, v192, v193
    v_cvt_pk_bf16_f32 v205, v194, v195
    v_exp_f32 v198, v110
    v_exp_f32 v199, v111
    v_mfma_f32_32x32x16_bf16 v[96:111], v[208:211], v[80:83], v[160:175]
    ds_read_b128 v[232:235], v245 offset:768
    v_exp_f32 v192, v112
    v_exp_f32 v193, v113
    v_cvt_pk_bf16_f32 v206, v196, v197
    v_cvt_pk_bf16_f32 v207, v198, v199
    v_exp_f32 v194, v114
    v_exp_f32 v195, v115
    v_mfma_f32_32x32x16_bf16 v[128:143], v[236:239], v[204:207], v[128:143]
    v_exp_f32 v196, v116
    v_exp_f32 v197, v117
    v_cvt_pk_bf16_f32 v200, v192, v193
    v_cvt_pk_bf16_f32 v201, v194, v195
    v_exp_f32 v198, v118
    v_exp_f32 v199, v119
    v_mfma_f32_32x32x8bf16_1k v[96:111], v[216:217], v[84:85], v[96:111]
    s_cmp_gt_u32 s67, 5
    s_cbranch_scc1 AT_sk_14
    s_add_u32 m0, m0, 4096
    s_nop 0
    buffer_load_dwordx4 v246, s[48:51], s65 offen sc1 lds
    buffer_load_dwordx4 v246, s[48:51], s65 offen offset:1024 sc1 lds
AT_sk_14:
    v_exp_f32 v192, v120
    v_exp_f32 v193, v121
    v_cvt_pk_bf16_f32 v202, v196, v197
    v_cvt_pk_bf16_f32 v203, v198, v199
    v_exp_f32 v194, v122
    v_exp_f32 v195, v123
    v_mfma_f32_32x32x16_bf16 v[144:159], v[228:231], v[200:203], v[144:159]
    s_waitcnt lgkmcnt(1)
    s_xor_b32 s68, s68, 32768
    s_add_u32 s69, s69, 22528
    v_exp_f32 v196, v124
    v_exp_f32 v197, v125
    v_cvt_pk_bf16_f32 v204, v192, v193
    v_cvt_pk_bf16_f32 v205, v194, v195
    v_exp_f32 v198, v126
    v_exp_f32 v199, v127
    v_xor_b32 v240, 32768, v240
    v_xor_b32 v241, 32768, v241
    v_xor_b32 v242, 32768, v242
    v_xor_b32 v243, 32768, v243
    v_xor_b32 v244, 32768, v244
    v_xor_b32 v245, 32768, v245
    s_add_u32 s67, s67, 1
    s_cmp_lt_u32 s67, 8
    s_cbranch_scc1 AT_loop_11
    s_setprio 0
    v_cvt_pk_bf16_f32 v206, v196, v197
    v_cvt_pk_bf16_f32 v207, v198, v199
    s_nop 1
    v_mfma_f32_32x32x16_bf16 v[144:159], v[236:239], v[204:207], v[144:159]
    s_nop 15
    s_nop 1
    v_mov_b32 v22, v136
    v_mov_b32 v20, v136
    s_nop 1
    v_permlane32_swap_b32 v22, v20
    v_mov_b32 v22, v152
    v_mov_b32 v21, v152
    s_nop 1
    v_permlane32_swap_b32 v22, v21
    s_mov_b32 s64, 0
    s_cmp_lg_u32 s70, 0
    s_cbranch_scc1 AT_nochk_18
    v_mov_b32 v24, 0
    v_mov_b32 v25, 0
    v_mov_b32 v26, 0
    v_pk_fma_f32 v[24:25], v[128:129], v[26:27], v[24:25] op_sel_hi:[1,0,1]
    v_pk_fma_f32 v[24:25], v[130:131], v[26:27], v[24:25] op_sel_hi:[1,0,1]
    v_pk_fma_f32 v[24:25], v[132:133], v[26:27], v[24:25] op_sel_hi:[1,0,1]
    v_pk_fma_f32 v[24:25], v[134:135], v[26:27], v[24:25] op_sel_hi:[1,0,1]
    v_pk_fma_f32 v[24:25], v[136:137], v[26:27], v[24:25] op_sel_hi:[1,0,1]
    v_pk_fma_f32 v[24:25], v[138:139], v[26:27], v[24:25] op_sel_hi:[1,0,1]
    v_pk_fma_f32 v[24:25], v[144:145], v[26:27], v[24:25] op_sel_hi:[1,0,1]
    v_pk_fma_f32 v[24:25], v[146:147], v[26:27], v[24:25] op_sel_hi:[1,0,1]
    v_pk_fma_f32 v[24:25], v[148:149], v[26:27], v[24:25] op_sel_hi:[1,0,1]
    v_pk_fma_f32 v[24:25], v[150:151], v[26:27], v[24:25] op_sel_hi:[1,0,1]
    v_pk_fma_f32 v[24:25], v[152:153], v[26:27], v[24:25] op_sel_hi:[1,0,1]
    v_pk_fma_f32 v[24:25], v[154:155], v[26:27], v[24:25] op_sel_hi:[1,0,1]
    v_min_f32 v23, v20, v21
    v_max_f32 v22, v20, v21
    v_add_f32 v24, v24, v25
    v_add_f32 v24, v24, v22
    v_cmp_nle_f32 vcc, 0x21800000, v23
    s_mov_b32 s65, 0x71800000
    v_cmp_nge_f32 s[74:75], s65, v24
    s_nop 1
    s_or_b64 vcc, vcc, s[74:75]
    s_cmp_lg_u64 vcc, 0
    s_cselect_b32 s64, 1, 0
AT_nochk_18:
    v_rcp_f32 v22, v20
    v_rcp_f32 v23, v21
    v_mov_b32 v24, s64
    s_lshl_b32 s65, s4, 2
    s_add_u32 s65, s65, 80896
    v_mov_b32 v25, s65
    ds_write_b32 v25, v24
    v_lshlrev_b32 v26, 3, v3
    v_lshl_add_u32 v26, v2, 8, v26
    s_mul_i32 s65, s4, 1280
    s_mul_i32 s66, s5, 5120
    s_add_u32 s65, s65, s66
    s_add_u32 s65, s65, 57344
    v_add_u32 v27, s65, v26
    s_mul_i32 s66, s5, -10240
    s_add_u32 s66, s66, 5120
    v_add_u32 v28, s66, v27
    v_mul_f32 v128, v22, v128
    v_mul_f32 v129, v22, v129
    v_mul_f32 v130, v22, v130
    v_mul_f32 v131, v22, v131
    v_mul_f32 v132, v22, v132
    v_mul_f32 v133, v22, v133
    v_mul_f32 v134, v22, v134
    v_mul_f32 v135, v22, v135
    v_mul_f32 v136, v22, v136
    v_mul_f32 v137, v22, v137
    v_mul_f32 v138, v22, v138
    v_mul_f32 v139, v22, v139
    v_cvt_pk_bf16_f32 v32, v128, v129
    v_cvt_pk_bf16_f32 v33, v130, v131
    v_cvt_pk_bf16_f32 v34, v132, v133
    v_cvt_pk_bf16_f32 v35, v134, v135
    v_cvt_pk_bf16_f32 v36, v136, v137
    v_cvt_pk_bf16_f32 v37, v138, v139
    ds_write_b64 v27, v[32:33]
    ds_write_b64 v27, v[34:35] offset:512
    s_mov_b32 exec_hi, 0
    ds_write_b64 v27, v[36:37] offset:1024
    s_mov_b64 exec, -1
    v_mul_f32 v144, v23, v144
    v_mul_f32 v145, v23, v145
    v_mul_f32 v146, v23, v146
    v_mul_f32 v147, v23, v147
    v_mul_f32 v148, v23, v148
    v_mul_f32 v149, v23, v149
    v_mul_f32 v150, v23, v150
    v_mul_f32 v151, v23, v151
    v_mul_f32 v152, v23, v152
    v_mul_f32 v153, v23, v153
    v_mul_f32 v154, v23, v154
    v_mul_f32 v155, v23, v155
    v_cvt_pk_bf16_f32 v40, v144, v145
    v_cvt_pk_bf16_f32 v41, v146, v147
    v_cvt_pk_bf16_f32 v42, v148, v149
    v_cvt_pk_bf16_f32 v43, v150, v151
    v_cvt_pk_bf16_f32 v44, v152, v153
    v_cvt_pk_bf16_f32 v45, v154, v155
    ds_write_b64 v28, v[40:41]
    ds_write_b64 v28, v[42:43] offset:512
    s_mov_b32 exec_hi, 0
    ds_write_b64 v28, v[44:45] offset:1024
    s_mov_b64 exec, -1
    s_waitcnt lgkmcnt(0)
    s_barrier
    v_mov_b32 v23, 80896
    ds_read_b128 v[48:51], v23
    v_lshlrev_b32 v26, 3, v3
    v_lshl_add_u32 v26, v2, 9, v26
    v_add_u32 v26, 57344, v26
    s_add_u32 s64, s4, 0
    s_cmp_ge_u32 s64, 5
    s_cselect_b32 s65, 1, 0
    s_mul_i32 s66, s65, 5
    s_sub_u32 s66, s64, s66
    s_mul_i32 s74, s65, 5120
    s_lshl_b32 s75, s66, 10
    s_add_u32 s74, s74, s75
    v_add_u32 v27, s74, v26
    ds_read2_b64 v[32:35], v27 offset0:0 offset1:32
    s_lshl_b32 s74, s35, 1
    s_add_u32 s74, s74, s65
    s_mul_i32 s74, s74, 40
    s_mul_i32 s75, s36, 5
    s_add_u32 s74, s74, s75
    s_add_u32 s74, s74, s66
    s_lshl_b32 s98, s74, 10
    s_add_u32 s64, s4, 4
    s_cmp_ge_u32 s64, 5
    s_cselect_b32 s65, 1, 0
    s_mul_i32 s66, s65, 5
    s_sub_u32 s66, s64, s66
    s_mul_i32 s74, s65, 5120
    s_lshl_b32 s75, s66, 10
    s_add_u32 s74, s74, s75
    v_add_u32 v27, s74, v26
    ds_read2_b64 v[36:39], v27 offset0:0 offset1:32
    s_lshl_b32 s74, s35, 1
    s_add_u32 s74, s74, s65
    s_mul_i32 s74, s74, 40
    s_mul_i32 s75, s36, 5
    s_add_u32 s74, s74, s75
    s_add_u32 s74, s74, s66
    s_lshl_b32 s99, s74, 10
    s_add_u32 s64, s4, 8
    s_cmp_ge_u32 s64, 5
    s_cselect_b32 s65, 1, 0
    s_mul_i32 s66, s65, 5
    s_sub_u32 s66, s64, s66
    s_mul_i32 s74, s65, 5120
    s_lshl_b32 s75, s66, 10
    s_add_u32 s74, s74, s75
    v_add_u32 v27, s74, v26
    ds_read2_b64 v[40:43], v27 offset0:0 offset1:32
    s_lshl_b32 s74, s35, 1
    s_add_u32 s74, s74, s65
    s_mul_i32 s74, s74, 40
    s_mul_i32 s75, s36, 5
    s_add_u32 s74, s74, s75
    s_add_u32 s74, s74, s66
    s_lshl_b32 s100, s74, 10
    s_cmp_lt_u32 s64, 10
    s_cselect_b32 s100, s100, 0x40000000
    s_waitcnt lgkmcnt(0)
    v_or_b32 v48, v48, v49
    v_or3_b32 v48, v48, v50, v51
    s_nop 0
    v_readfirstlane_b32 s64, v48
    s_nop 3
    s_cmp_eq_u32 s64, 0
    s_cbranch_scc1 AT_ok_15
    s_setprio 0
    v_mov_b32 v20, 0xff800000
    v_mov_b32 v21, 0xff800000
    s_mov_b32 s67, 0
AT_mc_16:
    s_barrier
    s_mov_b32 s68, 36864
    s_mul_i32 s69, s67, 22528
    s_mul_i32 s64, s4, 6144
    s_add_u32 m0, s68, s64
    s_add_u32 s65, s69, 4096
    buffer_load_dwordx4 v246, s[48:51], s69 offen sc1 lds
    buffer_load_dwordx4 v246, s[48:51], s69 offen offset:1024 sc1 lds
    buffer_load_dwordx4 v246, s[48:51], s69 offen offset:2048 sc1 lds
    buffer_load_dwordx4 v246, s[48:51], s69 offen offset:3072 sc1 lds
    s_add_u32 m0, m0, 4096
    s_nop 0
    buffer_load_dwordx4 v246, s[48:51], s65 offen sc1 lds
    buffer_load_dwordx4 v246, s[48:51], s65 offen offset:1024 sc1 lds
    s_waitcnt vmcnt(0)
    s_barrier
    v_mov_b32 v22, v240
    v_mov_b32 v23, v242
    s_mov_b32 s60, 0
AT_mt_17:
    ds_read_b128 v[208:211], v22
    ds_read_b64 v[216:217], v23
    s_waitcnt lgkmcnt(0)
    v_mfma_f32_32x32x16_bf16 v[96:111], v[208:211], v[80:83], 0
    v_mfma_f32_32x32x8bf16_1k v[96:111], v[216:217], v[84:85], v[96:111]
    v_mfma_f32_32x32x16_bf16 v[112:127], v[208:211], v[88:91], 0
    v_mfma_f32_32x32x8bf16_1k v[112:127], v[216:217], v[86:87], v[112:127]
    s_nop 15
    s_nop 1
    v_max3_f32 v20, v96, v97, v20
    v_max3_f32 v20, v98, v99, v20
    v_max3_f32 v20, v100, v101, v20
    v_max3_f32 v20, v102, v103, v20
    v_max3_f32 v20, v104, v105, v20
    v_max3_f32 v20, v106, v107, v20
    v_max3_f32 v20, v108, v109, v20
    v_max3_f32 v20, v110, v111, v20
    v_max3_f32 v21, v112, v113, v21
    v_max3_f32 v21, v114, v115, v21
    v_max3_f32 v21, v116, v117, v21
    v_max3_f32 v21, v118, v119, v21
    v_max3_f32 v21, v120, v121, v21
    v_max3_f32 v21, v122, v123, v21
    v_max3_f32 v21, v124, v125, v21
    v_max3_f32 v21, v126, v127, v21
    v_add_u32 v22, 1024, v22
    v_add_u32 v23, 256, v23
    s_add_u32 s60, s60, 1
    s_cmp_lt_u32 s60, 8
    s_cbranch_scc1 AT_mt_17
    s_add_u32 s67, s67, 1
    s_cmp_lt_u32 s67, 8
    s_cbranch_scc1 AT_mc_16
    v_mov_b32 v22, v20
    v_mov_b32 v23, v20
    s_nop 1
    v_permlane32_swap_b32 v22, v23
    s_nop 1
    v_max_f32 v22, v22, v23
    v_sub_f32 v22, 0, v22
    v_mov_b32 v160, v22
    v_mov_b32 v161, v22
    v_mov_b32 v162, v22
    v_mov_b32 v163, v22
    v_mov_b32 v164, v22
    v_mov_b32 v165, v22
    v_mov_b32 v166, v22
    v_mov_b32 v167, v22
    v_mov_b32 v168, v22
    v_mov_b32 v169, v22
    v_mov_b32 v170, v22
    v_mov_b32 v171, v22
    v_mov_b32 v172, v22
    v_mov_b32 v173, v22
    v_mov_b32 v174, v22
    v_mov_b32 v175, v22
    v_mov_b32 v22, v21
    v_mov_b32 v23, v21
    s_nop 1
    v_permlane32_swap_b32 v22, v23
    s_nop 1
    v_max_f32 v22, v22, v23
    v_sub_f32 v22, 0, v22
    v_mov_b32 v176, v22
    v_mov_b32 v177, v22
    v_mov_b32 v178, v22
    v_mov_b32 v179, v22
    v_mov_b32 v180, v22
    v_mov_b32 v181, v22
    v_mov_b32 v182, v22
    v_mov_b32 v183, v22
    v_mov_b32 v184, v22
    v_mov_b32 v185, v22
    v_mov_b32 v186, v22
    v_mov_b32 v187, v22
    v_mov_b32 v188, v22
    v_mov_b32 v189, v22
    v_mov_b32 v190, v22
    v_mov_b32 v191, v22
    s_barrier
    s_mov_b32 s68, 36864
    s_mov_b32 s69, 0
    s_mul_i32 s64, s4, 6144
    s_add_u32 m0, s68, s64
    s_add_u32 s65, s69, 4096
    buffer_load_dwordx4 v246, s[48:51], s69 offen sc1 lds
    buffer_load_dwordx4 v246, s[48:51], s69 offen offset:1024 sc1 lds
    buffer_load_dwordx4 v246, s[48:51], s69 offen offset:2048 sc1 lds
    buffer_load_dwordx4 v246, s[48:51], s69 offen offset:3072 sc1 lds
    s_add_u32 m0, m0, 4096
    s_nop 0
    buffer_load_dwordx4 v246, s[48:51], s65 offen sc1 lds
    buffer_load_dwordx4 v246, s[48:51], s65 offen offset:1024 sc1 lds
    s_mov_b32 s68, 4096
    s_mov_b32 s69, 22528
    s_mul_i32 s64, s4, 6144
    s_add_u32 m0, s68, s64
    s_add_u32 s65, s69, 4096
    buffer_load_dwordx4 v246, s[48:51], s69 offen sc1 lds
    buffer_load_dwordx4 v246, s[48:51], s69 offen offset:1024 sc1 lds
    buffer_load_dwordx4 v246, s[48:51], s69 offen offset:2048 sc1 lds
    buffer_load_dwordx4 v246, s[48:51], s69 offen offset:3072 sc1 lds
    s_add_u32 m0, m0, 4096
    s_nop 0
    buffer_load_dwordx4 v246, s[48:51], s65 offen sc1 lds
    buffer_load_dwordx4 v246, s[48:51], s65 offen offset:1024 sc1 lds
    s_mov_b32 s68, 36864
    s_mov_b32 s69, 45056
    v_mov_b32 v128, 0
    v_mov_b32 v129, 0
    v_mov_b32 v130, 0
    v_mov_b32 v131, 0
    v_mov_b32 v132, 0
    v_mov_b32 v133, 0
    v_mov_b32 v134, 0
    v_mov_b32 v135, 0
    v_mov_b32 v136, 0
    v_mov_b32 v137, 0
    v_mov_b32 v138, 0
    v_mov_b32 v139, 0
    v_mov_b32 v140, 0
    v_mov_b32 v141, 0
    v_mov_b32 v142, 0
    v_mov_b32 v143, 0
    v_mov_b32 v144, 0
    v_mov_b32 v145, 0
    v_mov_b32 v146, 0
    v_mov_b32 v147, 0
    v_mov_b32 v148, 0
    v_mov_b32 v149, 0
    v_mov_b32 v150, 0
    v_mov_b32 v151, 0
    v_mov_b32 v152, 0
    v_mov_b32 v153, 0
    v_mov_b32 v154, 0
    v_mov_b32 v155, 0
    v_mov_b32 v156, 0
    v_mov_b32 v157, 0
    v_mov_b32 v158, 0
    v_mov_b32 v159, 0
    v_mov_b32 v192, 0
    v_mov_b32 v193, 0
    v_mov_b32 v194, 0
    v_mov_b32 v195, 0
    v_mov_b32 v196, 0
    v_mov_b32 v197, 0
    v_mov_b32 v198, 0
    v_mov_b32 v199, 0
    v_mov_b32 v200, 0
    v_mov_b32 v201, 0
    v_mov_b32 v202, 0
    v_mov_b32 v203, 0
    v_mov_b32 v204, 0
    v_mov_b32 v205, 0
    v_mov_b32 v206, 0
    v_mov_b32 v207, 0
    v_mov_b32 v236, 0
    v_mov_b32 v237, 0
    v_mov_b32 v238, 0
    v_mov_b32 v239, 0
    s_mov_b32 s70, 1
    s_branch AT_pass_10
AT_ok_15:
    s_add_u32 s52, s32, 0x4a0000
    s_addc_u32 s53, s33, 0
    s_mov_b32 s54, 0x280000
    s_mov_b32 s55, 0x20000
    v_lshlrev_b32 v247, 4, v1
    buffer_store_dwordx4 v[32:35], v247, s[52:55], s98 offen sc1
    buffer_store_dwordx4 v[36:39], v247, s[52:55], s99 offen sc1
    buffer_store_dwordx4 v[40:43], v247, s[52:55], s100 offen sc1
    s_waitcnt vmcnt(0)
    s_barrier
    s_cmp_lg_u32 s4, 0
    s_cbranch_scc1 A_noarr_19
    s_lshl_b32 s64, s35, 2
    s_lshr_b32 s65, s36, 1
    s_add_u32 s64, s64, s65
    s_lshl_b32 s64, s64, 7
    s_add_u32 s56, s32, 0x4a00
    s_addc_u32 s57, s33, 0
    s_mov_b32 s58, 0x4000
    s_mov_b32 s59, 0x20000
    v_mov_b32 v20, s64
    v_mov_b32 v21, 1
    s_mov_b64 exec, 1
    buffer_atomic_add v21, v20, s[56:59], 0 offen sc1
    s_mov_b64 exec, -1
A_noarr_19:
    s_branch parallel_sum__grouped_kv_mqa__mixer_token_mlp__prompt_kernel_end
parallel_sum__grouped_kv_mqa__mixer_token_mlp__prompt_kernel_m:
    s_sub_u32 s34, s2, 256
    s_setprio 2
    s_and_b32 s35, s34, 7
    s_lshr_b32 s39, s34, 4
    s_lshl_b32 s39, s39, 3
    s_add_u32 s35, s35, s39
    s_lshr_b32 s36, s34, 3
    s_and_b32 s36, s36, 1
    v_lshrrev_b32 v1, 6, v0
    s_nop 0
    v_readfirstlane_b32 s4, v1
    v_and_b32 v1, 63, v0
    v_lshrrev_b32 v2, 4, v0
    v_and_b32 v3, 15, v0
    s_lshl_b32 s39, s35, 4
    v_add_u32 v4, s39, v2
    s_movk_i32 s39, 1280
    v_mul_lo_u32 v4, v4, s39
    v_lshl_add_u32 v4, v3, 4, v4
    s_mul_i32 s39, s4, 7168
    v_lshlrev_b32 v5, 4, v1
    v_add_u32 v5, s39, v5
    s_mov_b32 s37, 0x3f803f80
    s_mov_b32 s38, 0xffff0000
    v_mul_u32_u24 v40, 1296, v2
    v_lshl_add_u32 v40, v3, 4, v40
    v_add_u32 v40, 28672, v40
    v_mul_u32_u24 v41, 1344, v2
    v_lshl_add_u32 v41, v3, 4, v41
    v_add_u32 v41, 49408, v41
    v_mov_b32 v45, v2
    v_lshrrev_b32 v2, 5, v1
    v_and_b32 v3, 15, v1
    v_mul_u32_u24 v6, 1296, v3
    v_lshl_add_u32 v6, v2, 4, v6
    s_mul_i32 s60, s4, 320
    s_add_u32 s60, s60, 28672
    v_add_u32 v6, s60, v6
    v_lshrrev_b32 v7, 2, v3
    v_lshl_add_u32 v7, v2, 3, v7
    v_mul_u32_u24 v7, 40, v7
    v_and_b32 v42, 3, v1
    v_bfe_u32 v43, v1, 4, 1
    v_lshl_add_u32 v42, v43, 2, v42
    v_min_u32 v43, 4, v42
    v_lshrrev_b32 v44, 1, v42
    v_xor_b32 v44, v44, v42
    v_and_b32 v44, 1, v44
    v_mul_u32_u24 v44, 3, v44
    v_xor_b32 v44, v44, v42
    v_cmp_gt_u32 vcc, 4, v42
    s_nop 1
    v_cndmask_b32 v44, v43, v44, vcc
    s_cmp_eq_u32 s36, 0
    s_cselect_b64 vcc, -1, 0
    s_nop 1
    v_cndmask_b32 v44, v43, v44, vcc
    v_lshl_add_u32 v7, v44, 3, v7
    s_mul_i32 s60, s4, 6400
    s_add_u32 s60, s60, 0
    v_add_u32 v7, s60, v7
    s_waitcnt lgkmcnt(0)
    s_cmp_lg_u32 s34, 0
    s_cbranch_scc1 M_nozero_20
    v_cmp_gt_u32 vcc, 64, v0
    s_nop 1
    s_cmp_eq_u64 vcc, 0
    s_cbranch_scc1 M_nozero_20
    v_lshlrev_b32 v250, 7, v0
    v_mov_b32 v249, 0
    s_mov_b32 s56, s32
    s_mov_b32 s57, s33
    s_mov_b32 s58, 0x8a00
    s_mov_b32 s59, 0x20000
    buffer_store_dword v249, v250, s[56:59], 0 offen sc1
    v_add_u32 v251, 8192, v250
    buffer_store_dword v249, v251, s[56:59], 0 offen sc1
    v_add_u32 v251, 16384, v250
    buffer_store_dword v249, v251, s[56:59], 0 offen sc1
    v_add_u32 v251, 24576, v250
    buffer_store_dword v249, v251, s[56:59], 0 offen sc1
    v_add_u32 v251, 32768, v250
    buffer_store_dword v249, v251, s[56:59], 0 offen sc1
M_nozero_20:
    s_mov_b32 s40, s8
    s_mov_b32 s41, s9
    s_mov_b32 s42, 0x280000
    s_mov_b32 s43, 0x20000
    buffer_load_dwordx4 v[8:11], v4, s[40:43], 0 offen offset:0
    buffer_load_dwordx4 v[12:15], v4, s[40:43], 0 offen offset:256
    buffer_load_dwordx4 v[16:19], v4, s[40:43], 0 offen offset:512
    buffer_load_dwordx4 v[20:23], v4, s[40:43], 0 offen offset:768
    buffer_load_dwordx4 v[24:27], v4, s[40:43], 0 offen offset:1024
    s_cmp_eq_u32 s36, 0
    s_cselect_b32 s44, s12, s14
    s_cselect_b32 s45, s13, s15
    s_mov_b32 s46, 25600
    s_mov_b32 s47, 0x20000
    s_add_u32 m0, s39, 0
    s_nop 0
    buffer_load_dwordx4 v5, s[44:47], 0 offen offset:0 lds
    buffer_load_dwordx4 v5, s[44:47], 0 offen offset:1024 lds
    buffer_load_dwordx4 v5, s[44:47], 0 offen offset:2048 lds
    buffer_load_dwordx4 v5, s[44:47], 0 offen offset:3072 lds
    s_add_u32 m0, s39, 4096
    s_movk_i32 s60, 4096
    buffer_load_dwordx4 v5, s[44:47], s60 offen offset:0 lds
    buffer_load_dwordx4 v5, s[44:47], s60 offen offset:1024 lds
    buffer_load_dwordx4 v5, s[44:47], s60 offen offset:2048 lds
    s_setprio 1
    s_waitcnt vmcnt(7)
    s_lshl_b32 s64, s34, 2
    s_add_u32 s64, s64, s4
    s_cmp_lg_u32 s64, 0
    s_cbranch_scc1 M_noinit_21
    v_mov_b32 v252, 1
    v_mov_b32 v253, 0
    s_mov_b64 exec, 1
    s_mov_b32 s56, s30
    s_mov_b32 s57, s31
    s_mov_b32 s58, 0x100
    s_mov_b32 s59, 0x20000
    buffer_store_dword v252, v253, s[56:59], 0 offen sc1
    s_mov_b64 exec, -1
M_noinit_21:
    v_lshlrev_b32 v48, 16, v8
    v_and_b32 v49, s38, v8
    v_lshlrev_b32 v50, 16, v9
    v_and_b32 v51, s38, v9
    v_lshlrev_b32 v52, 16, v10
    v_and_b32 v53, s38, v10
    v_lshlrev_b32 v54, 16, v11
    v_and_b32 v55, s38, v11
    v_lshlrev_b32 v56, 16, v12
    v_and_b32 v57, s38, v12
    v_lshlrev_b32 v58, 16, v13
    v_and_b32 v59, s38, v13
    v_lshlrev_b32 v60, 16, v14
    v_and_b32 v61, s38, v14
    v_lshlrev_b32 v62, 16, v15
    v_and_b32 v63, s38, v15
    v_lshlrev_b32 v64, 16, v16
    v_and_b32 v65, s38, v16
    v_lshlrev_b32 v66, 16, v17
    v_and_b32 v67, s38, v17
    v_lshlrev_b32 v68, 16, v18
    v_and_b32 v69, s38, v18
    v_lshlrev_b32 v70, 16, v19
    v_and_b32 v71, s38, v19
    v_lshlrev_b32 v72, 16, v20
    v_and_b32 v73, s38, v20
    v_lshlrev_b32 v74, 16, v21
    v_and_b32 v75, s38, v21
    v_lshlrev_b32 v76, 16, v22
    v_and_b32 v77, s38, v22
    v_lshlrev_b32 v78, 16, v23
    v_and_b32 v79, s38, v23
    v_lshlrev_b32 v80, 16, v24
    v_and_b32 v81, s38, v24
    v_lshlrev_b32 v82, 16, v25
    v_and_b32 v83, s38, v25
    v_lshlrev_b32 v84, 16, v26
    v_and_b32 v85, s38, v26
    v_lshlrev_b32 v86, 16, v27
    v_and_b32 v87, s38, v27
    v_pk_add_f32 v[28:29], v[48:49], v[50:51]
    v_pk_mul_f32 v[30:31], v[48:49], v[48:49]
    v_pk_fma_f32 v[30:31], v[50:51], v[50:51], v[30:31]
    v_pk_add_f32 v[28:29], v[28:29], v[52:53]
    v_pk_fma_f32 v[30:31], v[52:53], v[52:53], v[30:31]
    v_pk_add_f32 v[28:29], v[28:29], v[54:55]
    v_pk_fma_f32 v[30:31], v[54:55], v[54:55], v[30:31]
    v_pk_add_f32 v[28:29], v[28:29], v[56:57]
    v_pk_fma_f32 v[30:31], v[56:57], v[56:57], v[30:31]
    v_pk_add_f32 v[28:29], v[28:29], v[58:59]
    v_pk_fma_f32 v[30:31], v[58:59], v[58:59], v[30:31]
    v_pk_add_f32 v[28:29], v[28:29], v[60:61]
    v_pk_fma_f32 v[30:31], v[60:61], v[60:61], v[30:31]
    v_pk_add_f32 v[28:29], v[28:29], v[62:63]
    v_pk_fma_f32 v[30:31], v[62:63], v[62:63], v[30:31]
    v_pk_add_f32 v[28:29], v[28:29], v[64:65]
    v_pk_fma_f32 v[30:31], v[64:65], v[64:65], v[30:31]
    v_pk_add_f32 v[28:29], v[28:29], v[66:67]
    v_pk_fma_f32 v[30:31], v[66:67], v[66:67], v[30:31]
    v_pk_add_f32 v[28:29], v[28:29], v[68:69]
    v_pk_fma_f32 v[30:31], v[68:69], v[68:69], v[30:31]
    v_pk_add_f32 v[28:29], v[28:29], v[70:71]
    v_pk_fma_f32 v[30:31], v[70:71], v[70:71], v[30:31]
    v_pk_add_f32 v[28:29], v[28:29], v[72:73]
    v_pk_fma_f32 v[30:31], v[72:73], v[72:73], v[30:31]
    v_pk_add_f32 v[28:29], v[28:29], v[74:75]
    v_pk_fma_f32 v[30:31], v[74:75], v[74:75], v[30:31]
    v_pk_add_f32 v[28:29], v[28:29], v[76:77]
    v_pk_fma_f32 v[30:31], v[76:77], v[76:77], v[30:31]
    v_pk_add_f32 v[28:29], v[28:29], v[78:79]
    v_pk_fma_f32 v[30:31], v[78:79], v[78:79], v[30:31]
    v_pk_add_f32 v[28:29], v[28:29], v[80:81]
    v_pk_fma_f32 v[30:31], v[80:81], v[80:81], v[30:31]
    v_pk_add_f32 v[28:29], v[28:29], v[82:83]
    v_pk_fma_f32 v[30:31], v[82:83], v[82:83], v[30:31]
    v_pk_add_f32 v[28:29], v[28:29], v[84:85]
    v_pk_fma_f32 v[30:31], v[84:85], v[84:85], v[30:31]
    v_pk_add_f32 v[28:29], v[28:29], v[86:87]
    v_pk_fma_f32 v[30:31], v[86:87], v[86:87], v[30:31]
    v_add_f32 v28, v28, v29
    v_add_f32 v30, v30, v31
    s_nop 0
    v_add_f32_dpp v28, v28, v28 row_ror:8 row_mask:0xf bank_mask:0xf
    v_add_f32_dpp v30, v30, v30 row_ror:8 row_mask:0xf bank_mask:0xf
    s_nop 0
    v_add_f32_dpp v28, v28, v28 row_ror:4 row_mask:0xf bank_mask:0xf
    v_add_f32_dpp v30, v30, v30 row_ror:4 row_mask:0xf bank_mask:0xf
    s_nop 0
    v_add_f32_dpp v28, v28, v28 row_ror:2 row_mask:0xf bank_mask:0xf
    v_add_f32_dpp v30, v30, v30 row_ror:2 row_mask:0xf bank_mask:0xf
    s_nop 0
    v_add_f32_dpp v28, v28, v28 row_ror:1 row_mask:0xf bank_mask:0xf
    v_add_f32_dpp v30, v30, v30 row_ror:1 row_mask:0xf bank_mask:0xf
    v_mul_f32 v28, 0x3acccccd, v28
    v_mul_f32 v30, 0x3acccccd, v30
    v_fma_f32 v30, -v28, v28, v30
    v_max_f32 v30, 0, v30
    v_add_f32 v30, 0x3727c5ac, v30
    v_rsq_f32 v32, v30
    s_nop 0
    v_mul_f32 v34, -v28, v32
    v_mov_b32 v36, v28
    v_mov_b32 v37, v32
    v_lshlrev_b32 v42, 3, v45
    v_add_u32 v42, 70912, v42
    ds_write_b64 v42, v[36:37]
    v_pk_fma_f32 v[48:49], v[48:49], v[32:33], v[34:35] op_sel_hi:[1,0,0]
    v_pk_fma_f32 v[50:51], v[50:51], v[32:33], v[34:35] op_sel_hi:[1,0,0]
    v_cvt_pk_bf16_f32 v8, v48, v49
    v_pk_fma_f32 v[52:53], v[52:53], v[32:33], v[34:35] op_sel_hi:[1,0,0]
    v_cvt_pk_bf16_f32 v9, v50, v51
    v_pk_fma_f32 v[54:55], v[54:55], v[32:33], v[34:35] op_sel_hi:[1,0,0]
    v_cvt_pk_bf16_f32 v10, v52, v53
    v_pk_fma_f32 v[56:57], v[56:57], v[32:33], v[34:35] op_sel_hi:[1,0,0]
    v_cvt_pk_bf16_f32 v11, v54, v55
    v_pk_fma_f32 v[58:59], v[58:59], v[32:33], v[34:35] op_sel_hi:[1,0,0]
    v_cvt_pk_bf16_f32 v12, v56, v57
    v_pk_fma_f32 v[60:61], v[60:61], v[32:33], v[34:35] op_sel_hi:[1,0,0]
    v_cvt_pk_bf16_f32 v13, v58, v59
    v_pk_fma_f32 v[62:63], v[62:63], v[32:33], v[34:35] op_sel_hi:[1,0,0]
    v_cvt_pk_bf16_f32 v14, v60, v61
    v_pk_fma_f32 v[64:65], v[64:65], v[32:33], v[34:35] op_sel_hi:[1,0,0]
    v_cvt_pk_bf16_f32 v15, v62, v63
    v_pk_fma_f32 v[66:67], v[66:67], v[32:33], v[34:35] op_sel_hi:[1,0,0]
    v_cvt_pk_bf16_f32 v16, v64, v65
    v_pk_fma_f32 v[68:69], v[68:69], v[32:33], v[34:35] op_sel_hi:[1,0,0]
    v_cvt_pk_bf16_f32 v17, v66, v67
    v_pk_fma_f32 v[70:71], v[70:71], v[32:33], v[34:35] op_sel_hi:[1,0,0]
    v_cvt_pk_bf16_f32 v18, v68, v69
    v_pk_fma_f32 v[72:73], v[72:73], v[32:33], v[34:35] op_sel_hi:[1,0,0]
    v_cvt_pk_bf16_f32 v19, v70, v71
    v_pk_fma_f32 v[74:75], v[74:75], v[32:33], v[34:35] op_sel_hi:[1,0,0]
    v_cvt_pk_bf16_f32 v20, v72, v73
    v_pk_fma_f32 v[76:77], v[76:77], v[32:33], v[34:35] op_sel_hi:[1,0,0]
    v_cvt_pk_bf16_f32 v21, v74, v75
    v_pk_fma_f32 v[78:79], v[78:79], v[32:33], v[34:35] op_sel_hi:[1,0,0]
    v_cvt_pk_bf16_f32 v22, v76, v77
    v_pk_fma_f32 v[80:81], v[80:81], v[32:33], v[34:35] op_sel_hi:[1,0,0]
    v_cvt_pk_bf16_f32 v23, v78, v79
    v_pk_fma_f32 v[82:83], v[82:83], v[32:33], v[34:35] op_sel_hi:[1,0,0]
    v_cvt_pk_bf16_f32 v24, v80, v81
    v_pk_fma_f32 v[84:85], v[84:85], v[32:33], v[34:35] op_sel_hi:[1,0,0]
    v_cvt_pk_bf16_f32 v25, v82, v83
    v_pk_fma_f32 v[86:87], v[86:87], v[32:33], v[34:35] op_sel_hi:[1,0,0]
    v_cvt_pk_bf16_f32 v26, v84, v85
    v_cvt_pk_bf16_f32 v27, v86, v87
    ds_write_b128 v40, v[8:11] offset:0
    ds_write_b128 v40, v[12:15] offset:256
    ds_write_b128 v40, v[16:19] offset:512
    ds_write_b128 v40, v[20:23] offset:768
    ds_write_b128 v40, v[24:27] offset:1024
    s_waitcnt vmcnt(0) lgkmcnt(0)
    s_barrier
    ds_read_b128 v[96:99], v6 offset:0
    ds_read_b64_tr_b16 v[100:101], v7 offset:0
    ds_read_b64_tr_b16 v[102:103], v7 offset:160
    ds_read_b128 v[104:107], v6 offset:32
    ds_read_b64_tr_b16 v[108:109], v7 offset:640
    ds_read_b64_tr_b16 v[110:111], v7 offset:800
    ds_read_b128 v[112:115], v6 offset:64
    ds_read_b64_tr_b16 v[116:117], v7 offset:1280
    ds_read_b64_tr_b16 v[118:119], v7 offset:1440
    ds_read_b128 v[120:123], v6 offset:96
    ds_read_b64_tr_b16 v[124:125], v7 offset:1920
    ds_read_b64_tr_b16 v[126:127], v7 offset:2080
    ds_read_b128 v[128:131], v6 offset:128
    ds_read_b64_tr_b16 v[132:133], v7 offset:2560
    ds_read_b64_tr_b16 v[134:135], v7 offset:2720
    s_cmp_lg_u32 s36, 0
    s_cbranch_scc1 M0_vj_22
    s_waitcnt lgkmcnt(12)
    v_mfma_f32_32x32x16_bf16 v[144:159], v[100:103], v[96:99], 0
    ds_read_b128 v[96:99], v6 offset:160
    ds_read_b64_tr_b16 v[100:101], v7 offset:3200
    ds_read_b64_tr_b16 v[102:103], v7 offset:3360
    s_waitcnt lgkmcnt(12)
    v_mfma_f32_32x32x16_bf16 v[144:159], v[108:111], v[104:107], v[144:159]
    ds_read_b128 v[104:107], v6 offset:192
    ds_read_b64_tr_b16 v[108:109], v7 offset:3840
    ds_read_b64_tr_b16 v[110:111], v7 offset:4000
    s_waitcnt lgkmcnt(12)
    v_mfma_f32_32x32x16_bf16 v[144:159], v[116:119], v[112:115], v[144:159]
    ds_read_b128 v[112:115], v6 offset:224
    ds_read_b64_tr_b16 v[116:117], v7 offset:4480
    ds_read_b64_tr_b16 v[118:119], v7 offset:4640
    s_waitcnt lgkmcnt(12)
    v_mfma_f32_32x32x16_bf16 v[144:159], v[124:127], v[120:123], v[144:159]
    ds_read_b128 v[120:123], v6 offset:256
    ds_read_b64_tr_b16 v[124:125], v7 offset:5120
    ds_read_b64_tr_b16 v[126:127], v7 offset:5280
    s_waitcnt lgkmcnt(12)
    v_mfma_f32_32x32x16_bf16 v[144:159], v[132:135], v[128:131], v[144:159]
    ds_read_b128 v[128:131], v6 offset:288
    ds_read_b64_tr_b16 v[132:133], v7 offset:5760
    ds_read_b64_tr_b16 v[134:135], v7 offset:5920
    s_waitcnt lgkmcnt(12)
    v_mfma_f32_32x32x16_bf16 v[144:159], v[100:103], v[96:99], v[144:159]
    s_waitcnt lgkmcnt(9)
    v_mfma_f32_32x32x16_bf16 v[144:159], v[108:111], v[104:107], v[144:159]
    s_waitcnt lgkmcnt(6)
    v_mfma_f32_32x32x16_bf16 v[144:159], v[116:119], v[112:115], v[144:159]
    s_waitcnt lgkmcnt(3)
    v_mfma_f32_32x32x16_bf16 v[144:159], v[124:127], v[120:123], v[144:159]
    s_waitcnt lgkmcnt(0)
    v_mfma_f32_32x32x16_bf16 v[144:159], v[132:135], v[128:131], v[144:159]
    s_branch M0_vje_23
M0_vj_22:
    s_waitcnt lgkmcnt(12)
    v_mfma_f32_32x32x16_bf16 v[144:159], v[96:99], v[100:103], 0
    ds_read_b128 v[96:99], v6 offset:160
    ds_read_b64_tr_b16 v[100:101], v7 offset:3200
    ds_read_b64_tr_b16 v[102:103], v7 offset:3360
    s_waitcnt lgkmcnt(12)
    v_mfma_f32_32x32x16_bf16 v[144:159], v[104:107], v[108:111], v[144:159]
    ds_read_b128 v[104:107], v6 offset:192
    ds_read_b64_tr_b16 v[108:109], v7 offset:3840
    ds_read_b64_tr_b16 v[110:111], v7 offset:4000
    s_waitcnt lgkmcnt(12)
    v_mfma_f32_32x32x16_bf16 v[144:159], v[112:115], v[116:119], v[144:159]
    ds_read_b128 v[112:115], v6 offset:224
    ds_read_b64_tr_b16 v[116:117], v7 offset:4480
    ds_read_b64_tr_b16 v[118:119], v7 offset:4640
    s_waitcnt lgkmcnt(12)
    v_mfma_f32_32x32x16_bf16 v[144:159], v[120:123], v[124:127], v[144:159]
    ds_read_b128 v[120:123], v6 offset:256
    ds_read_b64_tr_b16 v[124:125], v7 offset:5120
    ds_read_b64_tr_b16 v[126:127], v7 offset:5280
    s_waitcnt lgkmcnt(12)
    v_mfma_f32_32x32x16_bf16 v[144:159], v[128:131], v[132:135], v[144:159]
    ds_read_b128 v[128:131], v6 offset:288
    ds_read_b64_tr_b16 v[132:133], v7 offset:5760
    ds_read_b64_tr_b16 v[134:135], v7 offset:5920
    s_waitcnt lgkmcnt(12)
    v_mfma_f32_32x32x16_bf16 v[144:159], v[96:99], v[100:103], v[144:159]
    s_waitcnt lgkmcnt(9)
    v_mfma_f32_32x32x16_bf16 v[144:159], v[104:107], v[108:111], v[144:159]
    s_waitcnt lgkmcnt(6)
    v_mfma_f32_32x32x16_bf16 v[144:159], v[112:115], v[116:119], v[144:159]
    s_waitcnt lgkmcnt(3)
    v_mfma_f32_32x32x16_bf16 v[144:159], v[120:123], v[124:127], v[144:159]
    s_waitcnt lgkmcnt(0)
    v_mfma_f32_32x32x16_bf16 v[144:159], v[128:131], v[132:135], v[144:159]
M0_vje_23:
    v_pk_add_f32 v[28:29], v[48:49], v[50:51]
    v_pk_mul_f32 v[30:31], v[48:49], v[48:49]
    v_pk_fma_f32 v[30:31], v[50:51], v[50:51], v[30:31]
    v_pk_add_f32 v[28:29], v[28:29], v[52:53]
    v_pk_fma_f32 v[30:31], v[52:53], v[52:53], v[30:31]
    v_pk_add_f32 v[28:29], v[28:29], v[54:55]
    v_pk_fma_f32 v[30:31], v[54:55], v[54:55], v[30:31]
    v_pk_add_f32 v[28:29], v[28:29], v[56:57]
    v_pk_fma_f32 v[30:31], v[56:57], v[56:57], v[30:31]
    v_pk_add_f32 v[28:29], v[28:29], v[58:59]
    v_pk_fma_f32 v[30:31], v[58:59], v[58:59], v[30:31]
    v_pk_add_f32 v[28:29], v[28:29], v[60:61]
    v_pk_fma_f32 v[30:31], v[60:61], v[60:61], v[30:31]
    v_pk_add_f32 v[28:29], v[28:29], v[62:63]
    v_pk_fma_f32 v[30:31], v[62:63], v[62:63], v[30:31]
    v_pk_add_f32 v[28:29], v[28:29], v[64:65]
    v_pk_fma_f32 v[30:31], v[64:65], v[64:65], v[30:31]
    v_pk_add_f32 v[28:29], v[28:29], v[66:67]
    v_pk_fma_f32 v[30:31], v[66:67], v[66:67], v[30:31]
    v_pk_add_f32 v[28:29], v[28:29], v[68:69]
    v_pk_fma_f32 v[30:31], v[68:69], v[68:69], v[30:31]
    v_pk_add_f32 v[28:29], v[28:29], v[70:71]
    v_pk_fma_f32 v[30:31], v[70:71], v[70:71], v[30:31]
    v_pk_add_f32 v[28:29], v[28:29], v[72:73]
    v_pk_fma_f32 v[30:31], v[72:73], v[72:73], v[30:31]
    v_pk_add_f32 v[28:29], v[28:29], v[74:75]
    v_pk_fma_f32 v[30:31], v[74:75], v[74:75], v[30:31]
    v_pk_add_f32 v[28:29], v[28:29], v[76:77]
    v_pk_fma_f32 v[30:31], v[76:77], v[76:77], v[30:31]
    v_pk_add_f32 v[28:29], v[28:29], v[78:79]
    v_pk_fma_f32 v[30:31], v[78:79], v[78:79], v[30:31]
    v_pk_add_f32 v[28:29], v[28:29], v[80:81]
    v_pk_fma_f32 v[30:31], v[80:81], v[80:81], v[30:31]
    v_pk_add_f32 v[28:29], v[28:29], v[82:83]
    v_pk_fma_f32 v[30:31], v[82:83], v[82:83], v[30:31]
    v_pk_add_f32 v[28:29], v[28:29], v[84:85]
    v_pk_fma_f32 v[30:31], v[84:85], v[84:85], v[30:31]
    v_pk_add_f32 v[28:29], v[28:29], v[86:87]
    v_pk_fma_f32 v[30:31], v[86:87], v[86:87], v[30:31]
    v_add_f32 v28, v28, v29
    v_add_f32 v30, v30, v31
    s_nop 0
    v_add_f32_dpp v28, v28, v28 row_ror:8 row_mask:0xf bank_mask:0xf
    v_add_f32_dpp v30, v30, v30 row_ror:8 row_mask:0xf bank_mask:0xf
    s_nop 0
    v_add_f32_dpp v28, v28, v28 row_ror:4 row_mask:0xf bank_mask:0xf
    v_add_f32_dpp v30, v30, v30 row_ror:4 row_mask:0xf bank_mask:0xf
    s_nop 0
    v_add_f32_dpp v28, v28, v28 row_ror:2 row_mask:0xf bank_mask:0xf
    v_add_f32_dpp v30, v30, v30 row_ror:2 row_mask:0xf bank_mask:0xf
    s_nop 0
    v_add_f32_dpp v28, v28, v28 row_ror:1 row_mask:0xf bank_mask:0xf
    v_add_f32_dpp v30, v30, v30 row_ror:1 row_mask:0xf bank_mask:0xf
    v_mul_f32 v28, 0x3acccccd, v28
    v_mul_f32 v30, 0x3acccccd, v30
    v_fma_f32 v30, -v28, v28, v30
    v_max_f32 v30, 0, v30
    v_add_f32 v30, 0x3727c5ac, v30
    v_rsq_f32 v32, v30
    s_nop 0
    v_mul_f32 v34, -v28, v32
    v_lshlrev_b32 v42, 4, v1
    s_mul_i32 s60, s4, 3072
    s_add_u32 s60, s60, 67968
    v_add_u32 v43, s60, v42
    s_cmp_eq_u32 s4, 0
    s_cselect_b64 exec, 0, -1
    ds_write_b128 v43, v[144:147] offset:0
    ds_write_b128 v43, v[148:151] offset:1024
    ds_write_b128 v43, v[152:155] offset:2048
    s_mov_b64 exec, -1
    s_waitcnt lgkmcnt(0)
    s_barrier
    s_setprio 2
    s_cmp_lg_u32 s4, 0
    s_cbranch_scc1 M0_h_24
    v_add_u32 v43, 71040, v42
    ds_read_b128 v[96:99], v43 offset:0
    ds_read_b128 v[100:103], v43 offset:1024
    ds_read_b128 v[104:107], v43 offset:2048
    ds_read_b128 v[108:111], v43 offset:3072
    ds_read_b128 v[112:115], v43 offset:4096
    ds_read_b128 v[116:119], v43 offset:5120
    ds_read_b128 v[120:123], v43 offset:6144
    ds_read_b128 v[124:127], v43 offset:7168
    ds_read_b128 v[128:131], v43 offset:8192
    v_lshrrev_b32 v2, 5, v1
    v_and_b32 v3, 31, v1
    s_lshr_b32 s60, s35, 1
    s_and_b32 s61, s35, 1
    s_lshr_b32 s62, s60, 3
    s_and_b32 s60, s60, 7
    s_mul_i32 s62, s62, 22528
    s_add_u32 s48, s32, 0x10000
    s_addc_u32 s49, s33, 0
    s_mov_b32 s50, 0x2c000
    s_mov_b32 s51, 0x20000
    s_waitcnt lgkmcnt(0)
    v_add_f32 v96, v96, v108
    v_add_f32 v144, v144, v120
    v_add_f32 v97, v97, v109
    v_add_f32 v145, v145, v121
    v_add_f32 v98, v98, v110
    v_add_f32 v146, v146, v122
    v_add_f32 v99, v99, v111
    v_add_f32 v147, v147, v123
    v_add_f32 v100, v100, v112
    v_add_f32 v148, v148, v124
    v_add_f32 v101, v101, v113
    v_add_f32 v149, v149, v125
    v_add_f32 v102, v102, v114
    v_add_f32 v150, v150, v126
    v_add_f32 v103, v103, v115
    v_add_f32 v151, v151, v127
    v_add_f32 v104, v104, v116
    v_add_f32 v152, v152, v128
    v_add_f32 v105, v105, v117
    v_add_f32 v153, v153, v129
    v_add_f32 v106, v106, v118
    v_add_f32 v154, v154, v130
    v_add_f32 v107, v107, v119
    v_add_f32 v155, v155, v131
    v_add_f32 v144, v144, v96
    v_add_f32 v145, v145, v97
    v_add_f32 v146, v146, v98
    v_add_f32 v147, v147, v99
    v_add_f32 v148, v148, v100
    v_add_f32 v149, v149, v101
    v_add_f32 v150, v150, v102
    v_add_f32 v151, v151, v103
    v_add_f32 v152, v152, v104
    v_add_f32 v153, v153, v105
    v_add_f32 v154, v154, v106
    v_add_f32 v155, v155, v107
    s_cmp_lg_u32 s36, 0
    s_cbranch_scc1 M0_v_25
    v_cvt_pk_bf16_f32 v96, v144, v145
    v_cvt_pk_bf16_f32 v97, v146, v147
    v_cvt_pk_bf16_f32 v98, v148, v149
    v_cvt_pk_bf16_f32 v99, v150, v151
    v_cvt_pk_bf16_f32 v100, v152, v153
    v_cvt_pk_bf16_f32 v101, v154, v155
    v_lshlrev_b32 v42, 4, v3
    v_lshl_add_u32 v42, v2, 9, v42
    s_lshl_b32 s63, s60, 10
    s_add_u32 s63, s63, s62
    s_lshl_b32 s64, s61, 8
    s_add_u32 s63, s63, s64
    s_mov_b32 s66, 0x0000ffff
    s_mov_b32 s67, 0x0000ffff
    s_mov_b64 exec, s[66:67]
    buffer_store_dwordx4 v[96:99], v42, s[48:51], s63 offen sc1
    v_lshlrev_b32 v42, 3, v3
    s_lshl_b32 s63, s60, 8
    s_add_u32 s63, s63, s62
    s_lshl_b32 s64, s61, 7
    s_add_u32 s63, s63, s64
    s_add_u32 s63, s63, 8192
    s_mov_b64 exec, 0xffff
    buffer_store_dwordx2 v[100:101], v42, s[48:51], s63 offen sc1
    v_add_u32 v43, 70912, v42
    ds_read_b64 v[102:103], v43
    s_add_u32 s52, s32, 0xc000
    s_addc_u32 s53, s33, 0
    s_mov_b32 s54, 0x4000
    s_mov_b32 s55, 0x20000
    s_lshl_b32 s63, s35, 7
    s_waitcnt lgkmcnt(0)
    buffer_store_dwordx2 v[102:103], v42, s[52:55], s63 offen sc1
    s_mov_b64 exec, -1
    s_branch M0_kd_27
M0_v_25:
    v_cvt_pk_bf16_f32 v96, v144, v145
    v_cvt_pk_bf16_f32 v97, v146, v147
    v_cvt_pk_bf16_f32 v98, v148, v149
    v_cvt_pk_bf16_f32 v99, v150, v151
    v_cmp_eq_u32 vcc, 20, v3
    v_mov_b32 v42, s37
    s_nop 0
    v_cndmask_b32 v96, v96, v42, vcc
    v_cndmask_b32 v97, v97, v42, vcc
    v_cndmask_b32 v98, v98, v42, vcc
    v_cndmask_b32 v99, v99, v42, vcc
    v_cmp_lt_u32 vcc, 20, v3
    s_nop 1
    v_cndmask_b32 v96, v96, 0, vcc
    v_cndmask_b32 v97, v97, 0, vcc
    v_cndmask_b32 v98, v98, 0, vcc
    v_cndmask_b32 v99, v99, 0, vcc
    v_lshlrev_b32 v42, 4, v3
    v_mul_u32_u24 v43, 384, v2
    v_add_u32 v42, v42, v43
    s_lshl_b32 s63, s60, 1
    s_add_u32 s63, s63, s61
    s_mul_i32 s63, s63, 768
    s_add_u32 s63, s63, s62
    s_add_u32 s63, s63, 10240
    s_mov_b32 s66, 0x00ffffff
    s_mov_b32 s67, 0x00ffffff
    s_mov_b64 exec, s[66:67]
    buffer_store_dwordx4 v[96:99], v42, s[48:51], s63 offen sc1
    s_mov_b64 exec, -1
M0_kd_27:
    v_pk_fma_f32 v[48:49], v[48:49], v[32:33], v[34:35] op_sel_hi:[1,0,0]
    v_pk_fma_f32 v[50:51], v[50:51], v[32:33], v[34:35] op_sel_hi:[1,0,0]
    v_cvt_pk_bf16_f32 v8, v48, v49
    v_pk_fma_f32 v[52:53], v[52:53], v[32:33], v[34:35] op_sel_hi:[1,0,0]
    v_cvt_pk_bf16_f32 v9, v50, v51
    v_pk_fma_f32 v[54:55], v[54:55], v[32:33], v[34:35] op_sel_hi:[1,0,0]
    v_cvt_pk_bf16_f32 v10, v52, v53
    v_pk_fma_f32 v[56:57], v[56:57], v[32:33], v[34:35] op_sel_hi:[1,0,0]
    v_cvt_pk_bf16_f32 v11, v54, v55
    v_pk_fma_f32 v[58:59], v[58:59], v[32:33], v[34:35] op_sel_hi:[1,0,0]
    v_cvt_pk_bf16_f32 v12, v56, v57
    v_pk_fma_f32 v[60:61], v[60:61], v[32:33], v[34:35] op_sel_hi:[1,0,0]
    v_cvt_pk_bf16_f32 v13, v58, v59
    v_pk_fma_f32 v[62:63], v[62:63], v[32:33], v[34:35] op_sel_hi:[1,0,0]
    v_cvt_pk_bf16_f32 v14, v60, v61
    v_pk_fma_f32 v[64:65], v[64:65], v[32:33], v[34:35] op_sel_hi:[1,0,0]
    v_cvt_pk_bf16_f32 v15, v62, v63
    v_pk_fma_f32 v[66:67], v[66:67], v[32:33], v[34:35] op_sel_hi:[1,0,0]
    v_cvt_pk_bf16_f32 v16, v64, v65
    v_pk_fma_f32 v[68:69], v[68:69], v[32:33], v[34:35] op_sel_hi:[1,0,0]
    v_cvt_pk_bf16_f32 v17, v66, v67
    v_pk_fma_f32 v[70:71], v[70:71], v[32:33], v[34:35] op_sel_hi:[1,0,0]
    v_cvt_pk_bf16_f32 v18, v68, v69
    v_pk_fma_f32 v[72:73], v[72:73], v[32:33], v[34:35] op_sel_hi:[1,0,0]
    v_cvt_pk_bf16_f32 v19, v70, v71
    v_pk_fma_f32 v[74:75], v[74:75], v[32:33], v[34:35] op_sel_hi:[1,0,0]
    v_cvt_pk_bf16_f32 v20, v72, v73
    v_pk_fma_f32 v[76:77], v[76:77], v[32:33], v[34:35] op_sel_hi:[1,0,0]
    v_cvt_pk_bf16_f32 v21, v74, v75
    v_pk_fma_f32 v[78:79], v[78:79], v[32:33], v[34:35] op_sel_hi:[1,0,0]
    v_cvt_pk_bf16_f32 v22, v76, v77
    v_pk_fma_f32 v[80:81], v[80:81], v[32:33], v[34:35] op_sel_hi:[1,0,0]
    v_cvt_pk_bf16_f32 v23, v78, v79
    v_pk_fma_f32 v[82:83], v[82:83], v[32:33], v[34:35] op_sel_hi:[1,0,0]
    v_cvt_pk_bf16_f32 v24, v80, v81
    v_pk_fma_f32 v[84:85], v[84:85], v[32:33], v[34:35] op_sel_hi:[1,0,0]
    v_cvt_pk_bf16_f32 v25, v82, v83
    v_pk_fma_f32 v[86:87], v[86:87], v[32:33], v[34:35] op_sel_hi:[1,0,0]
    v_cvt_pk_bf16_f32 v26, v84, v85
    v_cvt_pk_bf16_f32 v27, v86, v87
    ds_write_b128 v41, v[8:11] offset:0
    ds_write_b128 v41, v[12:15] offset:256
    ds_write_b128 v41, v[16:19] offset:512
    ds_write_b128 v41, v[20:23] offset:768
    ds_write_b128 v41, v[24:27] offset:1024
    s_branch M0_end_26
M0_h_24:
    v_pk_fma_f32 v[48:49], v[48:49], v[32:33], v[34:35] op_sel_hi:[1,0,0]
    v_pk_fma_f32 v[50:51], v[50:51], v[32:33], v[34:35] op_sel_hi:[1,0,0]
    v_cvt_pk_bf16_f32 v8, v48, v49
    v_pk_fma_f32 v[52:53], v[52:53], v[32:33], v[34:35] op_sel_hi:[1,0,0]
    v_cvt_pk_bf16_f32 v9, v50, v51
    v_pk_fma_f32 v[54:55], v[54:55], v[32:33], v[34:35] op_sel_hi:[1,0,0]
    v_cvt_pk_bf16_f32 v10, v52, v53
    v_pk_fma_f32 v[56:57], v[56:57], v[32:33], v[34:35] op_sel_hi:[1,0,0]
    v_cvt_pk_bf16_f32 v11, v54, v55
    v_pk_fma_f32 v[58:59], v[58:59], v[32:33], v[34:35] op_sel_hi:[1,0,0]
    v_cvt_pk_bf16_f32 v12, v56, v57
    v_pk_fma_f32 v[60:61], v[60:61], v[32:33], v[34:35] op_sel_hi:[1,0,0]
    v_cvt_pk_bf16_f32 v13, v58, v59
    v_pk_fma_f32 v[62:63], v[62:63], v[32:33], v[34:35] op_sel_hi:[1,0,0]
    v_cvt_pk_bf16_f32 v14, v60, v61
    v_pk_fma_f32 v[64:65], v[64:65], v[32:33], v[34:35] op_sel_hi:[1,0,0]
    v_cvt_pk_bf16_f32 v15, v62, v63
    v_pk_fma_f32 v[66:67], v[66:67], v[32:33], v[34:35] op_sel_hi:[1,0,0]
    v_cvt_pk_bf16_f32 v16, v64, v65
    v_pk_fma_f32 v[68:69], v[68:69], v[32:33], v[34:35] op_sel_hi:[1,0,0]
    v_cvt_pk_bf16_f32 v17, v66, v67
    v_pk_fma_f32 v[70:71], v[70:71], v[32:33], v[34:35] op_sel_hi:[1,0,0]
    v_cvt_pk_bf16_f32 v18, v68, v69
    v_pk_fma_f32 v[72:73], v[72:73], v[32:33], v[34:35] op_sel_hi:[1,0,0]
    v_cvt_pk_bf16_f32 v19, v70, v71
    v_pk_fma_f32 v[74:75], v[74:75], v[32:33], v[34:35] op_sel_hi:[1,0,0]
    v_cvt_pk_bf16_f32 v20, v72, v73
    v_pk_fma_f32 v[76:77], v[76:77], v[32:33], v[34:35] op_sel_hi:[1,0,0]
    v_cvt_pk_bf16_f32 v21, v74, v75
    v_pk_fma_f32 v[78:79], v[78:79], v[32:33], v[34:35] op_sel_hi:[1,0,0]
    v_cvt_pk_bf16_f32 v22, v76, v77
    v_pk_fma_f32 v[80:81], v[80:81], v[32:33], v[34:35] op_sel_hi:[1,0,0]
    v_cvt_pk_bf16_f32 v23, v78, v79
    v_pk_fma_f32 v[82:83], v[82:83], v[32:33], v[34:35] op_sel_hi:[1,0,0]
    v_cvt_pk_bf16_f32 v24, v80, v81
    v_pk_fma_f32 v[84:85], v[84:85], v[32:33], v[34:35] op_sel_hi:[1,0,0]
    v_cvt_pk_bf16_f32 v25, v82, v83
    v_pk_fma_f32 v[86:87], v[86:87], v[32:33], v[34:35] op_sel_hi:[1,0,0]
    v_cvt_pk_bf16_f32 v26, v84, v85
    v_cvt_pk_bf16_f32 v27, v86, v87
    ds_write_b128 v41, v[8:11] offset:0
    ds_write_b128 v41, v[12:15] offset:256
    ds_write_b128 v41, v[16:19] offset:512
    ds_write_b128 v41, v[20:23] offset:768
    ds_write_b128 v41, v[24:27] offset:1024
M0_end_26:
    s_waitcnt lgkmcnt(0)
    s_barrier
    v_lshrrev_b32 v2, 5, v1
    v_and_b32 v3, 15, v1
    v_lshrrev_b32 v7, 2, v3
    v_lshl_add_u32 v7, v2, 3, v7
    v_mul_u32_u24 v7, 1344, v7
    v_and_b32 v42, 3, v1
    v_bfe_u32 v43, v1, 4, 1
    v_lshl_add_u32 v42, v43, 2, v42
    v_lshl_add_u32 v7, v42, 3, v7
    s_mul_i32 s60, s36, 10
    s_add_u32 s60, s60, s4
    s_lshl_b32 s63, s60, 6
    s_add_u32 s63, s63, 49408
    v_add_u32 v7, s63, v7
    ds_read_b64_tr_b16 v[96:97], v7 offset:0
    ds_read_b64_tr_b16 v[98:99], v7 offset:5376
    ds_read_b64_tr_b16 v[100:101], v7 offset:256
    ds_read_b64_tr_b16 v[102:103], v7 offset:5632
    ds_read_b64_tr_b16 v[104:105], v7 offset:512
    ds_read_b64_tr_b16 v[106:107], v7 offset:5888
    s_add_u32 s48, s32, 0x40000
    s_addc_u32 s49, s33, 0
    s_mov_b32 s50, 0x280000
    s_mov_b32 s51, 0x20000
    v_lshlrev_b32 v6, 4, v1
    s_lshl_b32 s63, s60, 7
    s_add_u32 s63, s63, s35
    s_lshl_b32 s63, s63, 10
    s_waitcnt lgkmcnt(0)
    buffer_store_dwordx4 v[96:99], v6, s[48:51], s63 offen sc1
    s_add_u32 s63, s63, 524288
    buffer_store_dwordx4 v[100:103], v6, s[48:51], s63 offen sc1
    s_add_u32 s63, s63, 524288
    s_cmp_lt_u32 s4, 2
    s_cselect_b32 s63, s63, 0x40000000
    buffer_store_dwordx4 v[104:107], v6, s[48:51], s63 offen sc1
    s_mov_b32 s56, s30
    s_mov_b32 s57, s31
    s_mov_b32 s58, 0x100
    s_mov_b32 s59, 0x20000
    v_mov_b32 v254, 0
    buffer_load_dword v254, v254, s[56:59], 0 offen sc1
    s_waitcnt vmcnt(0)
    s_barrier
    s_cmp_lg_u32 s4, 0
    s_cbranch_scc1 M_noarr_28
    s_mov_b32 s100, 0
INIT_29:
    v_cmp_eq_u32 vcc, 0, v254
    s_nop 1
    s_cmp_eq_u64 vcc, 0
    s_cbranch_scc1 INITE_30
    s_sleep 2
    s_mov_b32 s56, s30
    s_mov_b32 s57, s31
    s_mov_b32 s58, 0x100
    s_mov_b32 s59, 0x20000
    v_mov_b32 v254, 0
    buffer_load_dword v254, v254, s[56:59], 0 offen sc1
    s_waitcnt vmcnt(0)
    s_add_u32 s100, s100, 1
    s_cmp_lt_u32 s100, 65536
    s_cbranch_scc1 INIT_29
INITE_30:
    s_and_b32 s64, s34, 63
    s_lshl_b32 s64, s64, 7
    s_add_u32 s56, s32, 0xa00
    s_addc_u32 s57, s33, 0
    s_mov_b32 s58, 0x8000
    s_mov_b32 s59, 0x20000
    v_mov_b32 v252, s64
    v_mov_b32 v253, 1
    s_mov_b64 exec, 1
    buffer_atomic_add v253, v252, s[56:59], 0 offen sc1
    s_mov_b64 exec, -1
M_noarr_28:
    s_and_b32 s60, s34, 7
    s_lshr_b32 s61, s34, 3
    s_mul_hi_u32 s62, s61, 0x24924925
    s_mul_i32 s36, s62, 7
    s_sub_u32 s36, s61, s36
    s_lshl_b32 s62, s62, 3
    s_add_u32 s35, s60, s62
    v_lshrrev_b32 v1, 6, v0
    s_nop 0
    v_readfirstlane_b32 s4, v1
    v_and_b32 v1, 63, v0
    v_lshrrev_b32 v8, 5, v1
    v_and_b32 v9, 31, v1
    s_mul_i32 s66, s4, 20480
    s_lshl_b32 s60, s35, 6
    v_add_u32 v236, s60, v9
    v_lshlrev_b32 v30, 1, v236
    s_movk_i32 s61, 1280
    v_mul_lo_u32 v236, v236, s61
    s_mul_i32 s60, s36, 192
    s_lshl_b32 s61, s4, 4
    s_add_u32 s60, s60, s61
    v_lshl_add_u32 v236, v8, 3, v236
    v_add_u32 v236, s60, v236
    v_add_u32 v237, 40960, v236
    v_lshrrev_b32 v224, 3, v1
    s_mul_i32 s60, s4, 384
    v_add_u32 v224, s60, v224
    v_lshlrev_b32 v224, 12, v224
    v_bfe_u32 v225, v1, 4, 1
    v_lshlrev_b32 v225, 2, v225
    v_and_b32 v226, 7, v1
    v_xor_b32 v225, v225, v226
    v_lshl_add_u32 v224, v225, 4, v224
    s_lshl_b32 s60, s35, 7
    v_add_u32 v224, s60, v224
    s_lshl_b32 s60, s4, 3
    v_add_u32 v225, s60, v9
    v_and_b32 v225, 31, v225
    v_lshl_add_u32 v225, v8, 5, v225
    v_lshlrev_b32 v230, 4, v225
    s_mul_i32 s60, s36, 3
    s_mul_i32 s61, s4, 24
    s_add_u32 s62, s60, 0
    s_min_u32 s62, s62, 19
    s_mul_i32 s62, s62, 96
    s_add_u32 s62, s62, s61
    s_lshl_b32 s62, s62, 10
    v_add_u32 v225, s62, v230
    s_add_u32 s62, s60, 1
    s_min_u32 s62, s62, 19
    s_mul_i32 s62, s62, 96
    s_add_u32 s62, s62, s61
    s_lshl_b32 s62, s62, 10
    v_add_u32 v226, s62, v230
    s_add_u32 s62, s60, 2
    s_min_u32 s62, s62, 19
    s_mul_i32 s62, s62, 96
    s_add_u32 s62, s62, s61
    s_lshl_b32 s62, s62, 10
    v_add_u32 v227, s62, v230
    v_bfe_u32 v231, v1, 2, 2
    v_lshl_add_u32 v230, v8, 2, v231
    v_lshlrev_b32 v230, 7, v230
    v_bfe_u32 v232, v1, 4, 1
    v_bfe_u32 v233, v1, 1, 1
    v_lshl_add_u32 v232, v232, 1, v233
    v_lshrrev_b32 v233, 1, v231
    v_lshlrev_b32 v233, 2, v233
    v_xor_b32 v232, v232, v233
    v_lshl_add_u32 v230, v232, 4, v230
    v_and_b32 v232, 1, v1
    v_lshl_add_u32 v230, v232, 3, v230
    v_add_u32 v228, s66, v230
    v_xor_b32 v229, 64, v228
    v_lshl_add_u32 v230, v8, 3, v231
    v_mul_u32_u24 v230, 192, v230
    v_and_b32 v232, 3, v1
    v_bfe_u32 v233, v1, 4, 1
    v_lshl_add_u32 v232, v233, 2, v232
    s_lshl_b32 s60, s4, 1
    v_add_u32 v232, s60, v232
    v_and_b32 v232, 7, v232
    v_lshl_add_u32 v230, v232, 3, v230
    v_add_u32 v233, s66, v230
    s_mul_i32 s60, s4, 160
    s_mul_i32 s61, s36, 192
    s_movk_i32 s62, 1280
    v_add_u32 v112, 0, v1
    v_mul_u32_u24 v113, 5462, v112
    v_lshrrev_b32 v113, 16, v113
    v_mul_u32_u24 v114, 12, v113
    v_sub_u32 v114, v112, v114
    v_add_u32 v113, s60, v113
    v_mul_lo_u32 v113, v113, s62
    v_lshl_add_u32 v113, v114, 4, v113
    v_add_u32 v230, s61, v113
    v_add_u32 v112, 64, v1
    v_mul_u32_u24 v113, 5462, v112
    v_lshrrev_b32 v113, 16, v113
    v_mul_u32_u24 v114, 12, v113
    v_sub_u32 v114, v112, v114
    v_add_u32 v113, s60, v113
    v_mul_lo_u32 v113, v113, s62
    v_lshl_add_u32 v113, v114, 4, v113
    v_add_u32 v231, s61, v113
    v_add_u32 v112, 128, v1
    v_mul_u32_u24 v113, 5462, v112
    v_lshrrev_b32 v113, 16, v113
    v_mul_u32_u24 v114, 12, v113
    v_sub_u32 v114, v112, v114
    v_add_u32 v113, s60, v113
    v_mul_lo_u32 v113, v113, s62
    v_lshl_add_u32 v113, v114, 4, v113
    v_add_u32 v232, s61, v113
    v_lshlrev_b32 v112, 4, v1
    s_lshl_b32 s60, s35, 1
    s_mul_i32 s60, s60, 40
    s_mul_i32 s61, s4, 10
    s_add_u32 s60, s60, s61
    s_lshl_b32 s60, s60, 10
    v_add_u32 v234, s60, v112
    v_add_u32 v235, 40960, v234
    s_and_b32 s60, s34, 7
    s_lshr_b32 s61, s34, 3
    s_cmp_ge_u32 s61, 30
    s_cbranch_scc1 M1_end_31
    s_mul_hi_u32 s36, s61, 0x55555556
    s_mul_i32 s35, s36, 3
    s_sub_u32 s35, s61, s35
    s_mul_i32 s60, s60, 3
    s_add_u32 s35, s35, s60
    v_lshrrev_b32 v1, 6, v0
    s_nop 0
    v_readfirstlane_b32 s4, v1
    v_and_b32 v1, 63, v0
    s_mov_b32 s40, s20
    s_mov_b32 s41, s21
    s_mov_b32 s42, 0x600000
    s_mov_b32 s43, 0x20000
    s_add_u32 s44, s32, 0x40000
    s_addc_u32 s45, s33, 0
    s_mov_b32 s46, 0x280000
    s_mov_b32 s47, 0x20000
    v_lshrrev_b32 v2, 3, v1
    s_lshl_b32 s60, s4, 9
    v_add_u32 v2, s60, v2
    s_movk_i32 s60, 3072
    v_mul_lo_u32 v2, v2, s60
    v_bfe_u32 v3, v1, 4, 1
    v_lshlrev_b32 v3, 2, v3
    v_and_b32 v4, 7, v1
    v_xor_b32 v3, v3, v4
    v_lshl_add_u32 v2, v3, 4, v2
    s_lshl_b32 s60, s35, 7
    v_add_u32 v2, s60, v2
    s_lshl_b32 s60, s36, 8
    s_lshl_b32 s61, s4, 5
    s_add_u32 s60, s60, s61
    s_lshl_b32 s60, s60, 10
    v_lshlrev_b32 v3, 4, v1
    v_add_u32 v3, s60, v3
    s_and_b32 s61, s4, 1
    s_lshl_b32 s61, s61, 17
    s_xor_b32 s60, s61, 0x20000
    v_add_u32 v4, s60, v3
    v_add_u32 v3, s61, v3
    s_lshl_b32 s65, s4, 14
    v_lshrrev_b32 v8, 5, v1
    v_bfe_u32 v9, v1, 2, 2
    v_lshl_add_u32 v10, v8, 3, v9
    v_lshlrev_b32 v10, 7, v10
    v_bfe_u32 v11, v1, 4, 1
    v_bfe_u32 v12, v1, 1, 1
    v_lshl_add_u32 v11, v11, 1, v12
    v_lshrrev_b32 v12, 1, v9
    v_lshlrev_b32 v12, 2, v12
    v_xor_b32 v11, v11, v12
    v_lshl_add_u32 v10, v11, 4, v10
    v_and_b32 v11, 1, v1
    v_lshl_add_u32 v10, v11, 3, v10
    v_add_u32 v5, s65, v10
    s_lshr_b32 s60, s4, 1
    s_lshl_b32 s60, s60, 6
    v_xor_b32 v5, s60, v5
    v_xor_b32 v6, 64, v5
    s_mov_b32 s63, 0
    s_mov_b32 s64, 0
    s_add_u32 s56, s32, 0xa00
    s_addc_u32 s57, s33, 0
    s_mov_b32 s58, 0x8000
    s_mov_b32 s59, 0x20000
    v_and_b32 v20, 63, v0
    v_lshlrev_b32 v20, 7, v20
    s_cmp_lg_u32 s4, 0
    s_cbranch_scc1 POLLE_33
    s_mov_b32 s100, 0
    s_sleep 96
POLL_32:
    buffer_load_dword v21, v20, s[56:59], 0 offen sc1
    s_waitcnt vmcnt(0)
    v_cmp_ne_u32 vcc, 4, v21
    s_nop 1
    s_cmp_eq_u64 vcc, 0
    s_cbranch_scc1 POLLE_33
    s_sleep 16
    s_add_u32 s100, s100, 1
    s_cmp_lt_u32 s100, 65536
    s_cbranch_scc1 POLL_32
POLLE_33:
    s_barrier
    s_mul_i32 s60, s36, 208
    s_mul_i32 s61, s4, 52
    s_add_u32 s60, s60, s61
    v_add_u32 v13, s60, v1
    v_mul_u32_u24 v13, 3072, v13
    s_lshl_b32 s60, s35, 7
    s_mov_b32 exec_hi, 0xfffff
    buffer_load_dword v255, v13, s[40:43], s60 offen
    s_mov_b64 exec, -1
    s_mov_b32 s48, s22
    s_mov_b32 s49, s23
    s_mov_b32 s50, 0xc00
    s_mov_b32 s51, 0x20000
    s_lshr_b32 s60, s4, 1
    s_lshl_b32 s60, s60, 6
    s_lshl_b32 s61, s35, 7
    s_add_u32 s60, s60, s61
    v_lshlrev_b32 v9, 3, v8
    buffer_load_dwordx2 v[48:49], v9, s[48:51], s60 offen offset:0
    buffer_load_dwordx2 v[50:51], v9, s[48:51], s60 offen offset:16
    buffer_load_dwordx2 v[52:53], v9, s[48:51], s60 offen offset:32
    buffer_load_dwordx2 v[54:55], v9, s[48:51], s60 offen offset:48
    s_add_u32 m0, s65, 0
    s_add_u32 s60, s63, 0
    buffer_load_dwordx4 v2, s[40:43], s60 offen lds
    s_add_u32 m0, s65, 1024
    s_add_u32 s60, s63, 24576
    buffer_load_dwordx4 v2, s[40:43], s60 offen lds
    s_add_u32 m0, s65, 2048
    s_add_u32 s60, s63, 49152
    buffer_load_dwordx4 v2, s[40:43], s60 offen lds
    s_add_u32 m0, s65, 3072
    s_add_u32 s60, s63, 73728
    buffer_load_dwordx4 v2, s[40:43], s60 offen lds
    s_add_u32 s63, s63, 98304
    s_add_u32 m0, s65, 4096
    s_add_u32 s60, s63, 0
    buffer_load_dwordx4 v2, s[40:43], s60 offen lds
    s_add_u32 m0, s65, 5120
    s_add_u32 s60, s63, 24576
    buffer_load_dwordx4 v2, s[40:43], s60 offen lds
    s_add_u32 m0, s65, 6144
    s_add_u32 s60, s63, 49152
    buffer_load_dwordx4 v2, s[40:43], s60 offen lds
    s_add_u32 m0, s65, 7168
    s_add_u32 s60, s63, 73728
    buffer_load_dwordx4 v2, s[40:43], s60 offen lds
    s_add_u32 s63, s63, 98304
    buffer_load_dwordx4 v[64:67], v3, s[44:47], s64 offen offset:0 sc1
    buffer_load_dwordx4 v[68:71], v4, s[44:47], s64 offen offset:0 sc1
    buffer_load_dwordx4 v[72:75], v3, s[44:47], s64 offen offset:1024 sc1
    buffer_load_dwordx4 v[76:79], v4, s[44:47], s64 offen offset:1024 sc1
    s_add_u32 s64, s64, 2048
    buffer_load_dwordx4 v[80:83], v3, s[44:47], s64 offen offset:0 sc1
    buffer_load_dwordx4 v[84:87], v4, s[44:47], s64 offen offset:0 sc1
    buffer_load_dwordx4 v[88:91], v3, s[44:47], s64 offen offset:1024 sc1
    buffer_load_dwordx4 v[92:95], v4, s[44:47], s64 offen offset:1024 sc1
    s_add_u32 s64, s64, 2048
    s_setprio 0
    s_mov_b32 s62, 0
    s_waitcnt vmcnt(16)
    v_lshlrev_b32 v192, 16, v48
    v_and_b32 v193, 0xffff0000, v48
    v_lshlrev_b32 v194, 16, v49
    v_and_b32 v195, 0xffff0000, v49
    v_lshlrev_b32 v196, 16, v50
    v_and_b32 v197, 0xffff0000, v50
    v_lshlrev_b32 v198, 16, v51
    v_and_b32 v199, 0xffff0000, v51
    v_lshlrev_b32 v200, 16, v52
    v_and_b32 v201, 0xffff0000, v52
    v_lshlrev_b32 v202, 16, v53
    v_and_b32 v203, 0xffff0000, v53
    v_lshlrev_b32 v204, 16, v54
    v_and_b32 v205, 0xffff0000, v54
    v_lshlrev_b32 v206, 16, v55
    v_and_b32 v207, 0xffff0000, v55
    s_waitcnt vmcnt(4)
    ds_read_b64_tr_b16 v[32:33], v5 offset:0
    ds_read_b64_tr_b16 v[34:35], v5 offset:512
    ds_read_b64_tr_b16 v[36:37], v6 offset:0
    ds_read_b64_tr_b16 v[38:39], v6 offset:512
    ds_read_b64_tr_b16 v[40:41], v5 offset:2048
    ds_read_b64_tr_b16 v[42:43], v5 offset:2560
    ds_read_b64_tr_b16 v[44:45], v6 offset:2048
    ds_read_b64_tr_b16 v[46:47], v6 offset:2560
    s_waitcnt lgkmcnt(4)
    v_mfma_f32_32x32x16_bf16 v[128:143], v[32:35], v[64:67], v[192:207]
    v_mfma_f32_32x32x16_bf16 v[144:159], v[32:35], v[68:71], 0
    v_mfma_f32_32x32x16_bf16 v[160:175], v[36:39], v[64:67], 0
    buffer_load_dwordx4 v[64:67], v3, s[44:47], s64 offen offset:0 sc1
    v_mfma_f32_32x32x16_bf16 v[176:191], v[36:39], v[68:71], 0
    buffer_load_dwordx4 v[68:71], v4, s[44:47], s64 offen offset:0 sc1
    s_waitcnt lgkmcnt(0)
    v_mfma_f32_32x32x16_bf16 v[128:143], v[40:43], v[72:75], v[128:143]
    s_add_u32 m0, s65, 0
    s_add_u32 s60, s63, 0
    buffer_load_dwordx4 v2, s[40:43], s60 offen lds
    v_mfma_f32_32x32x16_bf16 v[144:159], v[40:43], v[76:79], v[144:159]
    s_add_u32 m0, s65, 1024
    s_add_u32 s60, s63, 24576
    buffer_load_dwordx4 v2, s[40:43], s60 offen lds
    v_mfma_f32_32x32x16_bf16 v[160:175], v[44:47], v[72:75], v[160:175]
    s_add_u32 m0, s65, 2048
    s_add_u32 s60, s63, 49152
    buffer_load_dwordx4 v2, s[40:43], s60 offen lds
    buffer_load_dwordx4 v[72:75], v3, s[44:47], s64 offen offset:1024 sc1
    v_mfma_f32_32x32x16_bf16 v[176:191], v[44:47], v[76:79], v[176:191]
    s_add_u32 m0, s65, 3072
    s_add_u32 s60, s63, 73728
    buffer_load_dwordx4 v2, s[40:43], s60 offen lds
    buffer_load_dwordx4 v[76:79], v4, s[44:47], s64 offen offset:1024 sc1
    s_add_u32 s63, s63, 98304
    s_add_u32 s64, s64, 2048
    s_waitcnt vmcnt(8)
    ds_read_b64_tr_b16 v[32:33], v5 offset:4096
    ds_read_b64_tr_b16 v[34:35], v5 offset:4608
    ds_read_b64_tr_b16 v[36:37], v6 offset:4096
    ds_read_b64_tr_b16 v[38:39], v6 offset:4608
    ds_read_b64_tr_b16 v[40:41], v5 offset:6144
    ds_read_b64_tr_b16 v[42:43], v5 offset:6656
    ds_read_b64_tr_b16 v[44:45], v6 offset:6144
    ds_read_b64_tr_b16 v[46:47], v6 offset:6656
    s_waitcnt lgkmcnt(4)
    v_mfma_f32_32x32x16_bf16 v[128:143], v[32:35], v[80:83], v[128:143]
    v_mfma_f32_32x32x16_bf16 v[144:159], v[32:35], v[84:87], v[144:159]
    v_mfma_f32_32x32x16_bf16 v[160:175], v[36:39], v[80:83], v[160:175]
    buffer_load_dwordx4 v[80:83], v3, s[44:47], s64 offen offset:0 sc1
    v_mfma_f32_32x32x16_bf16 v[176:191], v[36:39], v[84:87], v[176:191]
    buffer_load_dwordx4 v[84:87], v4, s[44:47], s64 offen offset:0 sc1
    s_waitcnt lgkmcnt(0)
    v_mfma_f32_32x32x16_bf16 v[128:143], v[40:43], v[88:91], v[128:143]
    s_add_u32 m0, s65, 4096
    s_add_u32 s60, s63, 0
    buffer_load_dwordx4 v2, s[40:43], s60 offen lds
    v_mfma_f32_32x32x16_bf16 v[144:159], v[40:43], v[92:95], v[144:159]
    s_add_u32 m0, s65, 5120
    s_add_u32 s60, s63, 24576
    buffer_load_dwordx4 v2, s[40:43], s60 offen lds
    v_mfma_f32_32x32x16_bf16 v[160:175], v[44:47], v[88:91], v[160:175]
    s_add_u32 m0, s65, 6144
    s_add_u32 s60, s63, 49152
    buffer_load_dwordx4 v2, s[40:43], s60 offen lds
    buffer_load_dwordx4 v[88:91], v3, s[44:47], s64 offen offset:1024 sc1
    v_mfma_f32_32x32x16_bf16 v[176:191], v[44:47], v[92:95], v[176:191]
    s_add_u32 m0, s65, 7168
    s_add_u32 s60, s63, 73728
    buffer_load_dwordx4 v2, s[40:43], s60 offen lds
    buffer_load_dwordx4 v[92:95], v4, s[44:47], s64 offen offset:1024 sc1
    s_add_u32 s63, s63, 98304
    s_add_u32 s64, s64, 2048
M1_loop_34:
    s_waitcnt vmcnt(8)
    ds_read_b64_tr_b16 v[32:33], v5 offset:0
    ds_read_b64_tr_b16 v[34:35], v5 offset:512
    ds_read_b64_tr_b16 v[36:37], v6 offset:0
    ds_read_b64_tr_b16 v[38:39], v6 offset:512
    ds_read_b64_tr_b16 v[40:41], v5 offset:2048
    ds_read_b64_tr_b16 v[42:43], v5 offset:2560
    ds_read_b64_tr_b16 v[44:45], v6 offset:2048
    ds_read_b64_tr_b16 v[46:47], v6 offset:2560
    s_waitcnt lgkmcnt(4)
    v_mfma_f32_32x32x16_bf16 v[128:143], v[32:35], v[64:67], v[128:143]
    v_mfma_f32_32x32x16_bf16 v[144:159], v[32:35], v[68:71], v[144:159]
    v_mfma_f32_32x32x16_bf16 v[160:175], v[36:39], v[64:67], v[160:175]
    buffer_load_dwordx4 v[64:67], v3, s[44:47], s64 offen offset:0 sc1
    v_mfma_f32_32x32x16_bf16 v[176:191], v[36:39], v[68:71], v[176:191]
    buffer_load_dwordx4 v[68:71], v4, s[44:47], s64 offen offset:0 sc1
    s_waitcnt lgkmcnt(0)
    v_mfma_f32_32x32x16_bf16 v[128:143], v[40:43], v[72:75], v[128:143]
    s_add_u32 m0, s65, 0
    s_add_u32 s60, s63, 0
    buffer_load_dwordx4 v2, s[40:43], s60 offen lds
    v_mfma_f32_32x32x16_bf16 v[144:159], v[40:43], v[76:79], v[144:159]
    s_add_u32 m0, s65, 1024
    s_add_u32 s60, s63, 24576
    buffer_load_dwordx4 v2, s[40:43], s60 offen lds
    v_mfma_f32_32x32x16_bf16 v[160:175], v[44:47], v[72:75], v[160:175]
    s_add_u32 m0, s65, 2048
    s_add_u32 s60, s63, 49152
    buffer_load_dwordx4 v2, s[40:43], s60 offen lds
    buffer_load_dwordx4 v[72:75], v3, s[44:47], s64 offen offset:1024 sc1
    v_mfma_f32_32x32x16_bf16 v[176:191], v[44:47], v[76:79], v[176:191]
    s_add_u32 m0, s65, 3072
    s_add_u32 s60, s63, 73728
    buffer_load_dwordx4 v2, s[40:43], s60 offen lds
    buffer_load_dwordx4 v[76:79], v4, s[44:47], s64 offen offset:1024 sc1
    s_add_u32 s63, s63, 98304
    s_add_u32 s64, s64, 2048
    s_waitcnt vmcnt(8)
    ds_read_b64_tr_b16 v[32:33], v5 offset:4096
    ds_read_b64_tr_b16 v[34:35], v5 offset:4608
    ds_read_b64_tr_b16 v[36:37], v6 offset:4096
    ds_read_b64_tr_b16 v[38:39], v6 offset:4608
    ds_read_b64_tr_b16 v[40:41], v5 offset:6144
    ds_read_b64_tr_b16 v[42:43], v5 offset:6656
    ds_read_b64_tr_b16 v[44:45], v6 offset:6144
    ds_read_b64_tr_b16 v[46:47], v6 offset:6656
    s_waitcnt lgkmcnt(4)
    v_mfma_f32_32x32x16_bf16 v[128:143], v[32:35], v[80:83], v[128:143]
    v_mfma_f32_32x32x16_bf16 v[144:159], v[32:35], v[84:87], v[144:159]
    v_mfma_f32_32x32x16_bf16 v[160:175], v[36:39], v[80:83], v[160:175]
    buffer_load_dwordx4 v[80:83], v3, s[44:47], s64 offen offset:0 sc1
    v_mfma_f32_32x32x16_bf16 v[176:191], v[36:39], v[84:87], v[176:191]
    buffer_load_dwordx4 v[84:87], v4, s[44:47], s64 offen offset:0 sc1
    s_waitcnt lgkmcnt(0)
    v_mfma_f32_32x32x16_bf16 v[128:143], v[40:43], v[88:91], v[128:143]
    s_add_u32 m0, s65, 4096
    s_add_u32 s60, s63, 0
    buffer_load_dwordx4 v2, s[40:43], s60 offen lds
    v_mfma_f32_32x32x16_bf16 v[144:159], v[40:43], v[92:95], v[144:159]
    s_add_u32 m0, s65, 5120
    s_add_u32 s60, s63, 24576
    buffer_load_dwordx4 v2, s[40:43], s60 offen lds
    v_mfma_f32_32x32x16_bf16 v[160:175], v[44:47], v[88:91], v[160:175]
    s_add_u32 m0, s65, 6144
    s_add_u32 s60, s63, 49152
    buffer_load_dwordx4 v2, s[40:43], s60 offen lds
    buffer_load_dwordx4 v[88:91], v3, s[44:47], s64 offen offset:1024 sc1
    v_mfma_f32_32x32x16_bf16 v[176:191], v[44:47], v[92:95], v[176:191]
    s_add_u32 m0, s65, 7168
    s_add_u32 s60, s63, 73728
    buffer_load_dwordx4 v2, s[40:43], s60 offen lds
    buffer_load_dwordx4 v[92:95], v4, s[44:47], s64 offen offset:1024 sc1
    s_add_u32 s63, s63, 98304
    s_add_u32 s64, s64, 2048
    s_add_u32 s62, s62, 1
    s_cmp_lt_u32 s62, 6
    s_cbranch_scc1 M1_loop_34
    s_waitcnt vmcnt(8)
    ds_read_b64_tr_b16 v[32:33], v5 offset:0
    ds_read_b64_tr_b16 v[34:35], v5 offset:512
    ds_read_b64_tr_b16 v[36:37], v6 offset:0
    ds_read_b64_tr_b16 v[38:39], v6 offset:512
    ds_read_b64_tr_b16 v[40:41], v5 offset:2048
    ds_read_b64_tr_b16 v[42:43], v5 offset:2560
    ds_read_b64_tr_b16 v[44:45], v6 offset:2048
    ds_read_b64_tr_b16 v[46:47], v6 offset:2560
    s_waitcnt lgkmcnt(4)
    v_mfma_f32_32x32x16_bf16 v[128:143], v[32:35], v[64:67], v[128:143]
    v_mfma_f32_32x32x16_bf16 v[144:159], v[32:35], v[68:71], v[144:159]
    v_mfma_f32_32x32x16_bf16 v[160:175], v[36:39], v[64:67], v[160:175]
    v_mfma_f32_32x32x16_bf16 v[176:191], v[36:39], v[68:71], v[176:191]
    s_waitcnt lgkmcnt(0)
    v_mfma_f32_32x32x16_bf16 v[128:143], v[40:43], v[72:75], v[128:143]
    v_mfma_f32_32x32x16_bf16 v[144:159], v[40:43], v[76:79], v[144:159]
    v_mfma_f32_32x32x16_bf16 v[160:175], v[44:47], v[72:75], v[160:175]
    v_mfma_f32_32x32x16_bf16 v[176:191], v[44:47], v[76:79], v[176:191]
    s_waitcnt vmcnt(0)
    ds_read_b64_tr_b16 v[32:33], v5 offset:4096
    ds_read_b64_tr_b16 v[34:35], v5 offset:4608
    ds_read_b64_tr_b16 v[36:37], v6 offset:4096
    ds_read_b64_tr_b16 v[38:39], v6 offset:4608
    ds_read_b64_tr_b16 v[40:41], v5 offset:6144
    ds_read_b64_tr_b16 v[42:43], v5 offset:6656
    ds_read_b64_tr_b16 v[44:45], v6 offset:6144
    ds_read_b64_tr_b16 v[46:47], v6 offset:6656
    s_waitcnt lgkmcnt(4)
    v_mfma_f32_32x32x16_bf16 v[128:143], v[32:35], v[80:83], v[128:143]
    v_mfma_f32_32x32x16_bf16 v[144:159], v[32:35], v[84:87], v[144:159]
    v_mfma_f32_32x32x16_bf16 v[160:175], v[36:39], v[80:83], v[160:175]
    v_mfma_f32_32x32x16_bf16 v[176:191], v[36:39], v[84:87], v[176:191]
    s_waitcnt lgkmcnt(0)
    v_mfma_f32_32x32x16_bf16 v[128:143], v[40:43], v[88:91], v[128:143]
    v_mfma_f32_32x32x16_bf16 v[144:159], v[40:43], v[92:95], v[144:159]
    v_mfma_f32_32x32x16_bf16 v[160:175], v[44:47], v[88:91], v[160:175]
    v_mfma_f32_32x32x16_bf16 v[176:191], v[44:47], v[92:95], v[176:191]
    s_setprio 2
    s_lshr_b32 s66, s34, 3
    s_mul_hi_u32 s67, s66, 0x24924925
    s_mul_i32 s68, s67, 7
    s_sub_u32 s68, s66, s68
    s_lshl_b32 s67, s67, 3
    s_and_b32 s69, s34, 7
    s_add_u32 s67, s67, s69
    s_mul_i32 s68, s68, 220
    s_mul_i32 s69, s4, 55
    s_add_u32 s68, s68, s69
    v_add_u32 v13, s68, v1
    v_lshlrev_b32 v13, 12, v13
    s_lshl_b32 s67, s67, 7
    s_mov_b32 s56, s24
    s_mov_b32 s57, s25
    s_mov_b32 s58, 0x600000
    s_mov_b32 s59, 0x20000
    s_mov_b32 exec_hi, 0x7fffff
    buffer_load_dword v255, v13, s[56:59], s67 offen
    s_mov_b64 exec, -1
    s_mul_i32 s66, s34, 27
    v_add_u32 v13, s66, v1
    v_lshlrev_b32 v13, 7, v13
    s_mov_b32 s56, s16
    s_mov_b32 s57, s17
    s_mov_b32 s58, 0xc8000
    s_mov_b32 s59, 0x20000
    s_mov_b32 exec_hi, 0
    s_mov_b32 exec_lo, 0x7ffffff
    buffer_load_dword v255, v13, s[56:59], 0 offen
    s_mov_b64 exec, -1
    s_nop 11
    s_barrier
    v_lshlrev_b32 v10, 4, v1
    s_xor_b32 s60, s4, 1
    s_mul_i32 s60, s60, 12288
    v_add_u32 v11, s60, v10
    ds_write_b128 v11, v[144:147] offset:0
    ds_write_b128 v11, v[148:151] offset:1024
    ds_write_b128 v11, v[152:155] offset:2048
    ds_write_b128 v11, v[156:159] offset:3072
    s_xor_b32 s60, s4, 2
    s_mul_i32 s60, s60, 12288
    v_add_u32 v11, s60, v10
    ds_write_b128 v11, v[160:163] offset:4096
    ds_write_b128 v11, v[164:167] offset:5120
    ds_write_b128 v11, v[168:171] offset:6144
    ds_write_b128 v11, v[172:175] offset:7168
    s_xor_b32 s60, s4, 3
    s_mul_i32 s60, s60, 12288
    v_add_u32 v11, s60, v10
    ds_write_b128 v11, v[176:179] offset:8192
    ds_write_b128 v11, v[180:183] offset:9216
    ds_write_b128 v11, v[184:187] offset:10240
    ds_write_b128 v11, v[188:191] offset:11264
    v_mov_b32 v12, 0xc0135761
    v_mov_b32 v13, 0xc0135761
    v_mov_b32 v14, 0xbdd2d3e8
    v_mov_b32 v15, 0xbdd2d3e8
    v_mov_b32 v16, 0x3f800000
    v_mov_b32 v17, 0x3f800000
    s_waitcnt lgkmcnt(0)
    s_barrier
    s_mul_i32 s60, s4, 12288
    v_add_u32 v11, s60, v10
    ds_read_b128 v[64:67], v11 offset:0
    ds_read_b128 v[68:71], v11 offset:1024
    ds_read_b128 v[72:75], v11 offset:2048
    ds_read_b128 v[76:79], v11 offset:3072
    ds_read_b128 v[80:83], v11 offset:4096
    ds_read_b128 v[84:87], v11 offset:5120
    ds_read_b128 v[88:91], v11 offset:6144
    ds_read_b128 v[92:95], v11 offset:7168
    ds_read_b128 v[96:99], v11 offset:8192
    ds_read_b128 v[100:103], v11 offset:9216
    ds_read_b128 v[104:107], v11 offset:10240
    ds_read_b128 v[108:111], v11 offset:11264
    s_waitcnt lgkmcnt(8)
    v_pk_add_f32 v[128:129], v[128:129], v[64:65]
    v_pk_add_f32 v[130:131], v[130:131], v[66:67]
    v_pk_add_f32 v[132:133], v[132:133], v[68:69]
    v_pk_add_f32 v[134:135], v[134:135], v[70:71]
    v_pk_add_f32 v[136:137], v[136:137], v[72:73]
    v_pk_add_f32 v[138:139], v[138:139], v[74:75]
    v_pk_add_f32 v[140:141], v[140:141], v[76:77]
    v_pk_add_f32 v[142:143], v[142:143], v[78:79]
    s_waitcnt lgkmcnt(4)
    v_pk_add_f32 v[128:129], v[128:129], v[80:81]
    v_pk_add_f32 v[130:131], v[130:131], v[82:83]
    v_pk_add_f32 v[132:133], v[132:133], v[84:85]
    v_pk_add_f32 v[134:135], v[134:135], v[86:87]
    v_pk_add_f32 v[136:137], v[136:137], v[88:89]
    v_pk_add_f32 v[138:139], v[138:139], v[90:91]
    v_pk_add_f32 v[140:141], v[140:141], v[92:93]
    v_pk_add_f32 v[142:143], v[142:143], v[94:95]
    s_waitcnt lgkmcnt(0)
    v_pk_add_f32 v[128:129], v[128:129], v[96:97]
    v_pk_add_f32 v[130:131], v[130:131], v[98:99]
    v_pk_add_f32 v[132:133], v[132:133], v[100:101]
    v_pk_add_f32 v[134:135], v[134:135], v[102:103]
    v_pk_add_f32 v[136:137], v[136:137], v[104:105]
    v_pk_add_f32 v[138:139], v[138:139], v[106:107]
    v_pk_add_f32 v[140:141], v[140:141], v[108:109]
    v_pk_add_f32 v[142:143], v[142:143], v[110:111]
    v_pk_mul_f32 v[64:65], v[128:129], v[128:129]
    v_pk_mul_f32 v[66:67], v[130:131], v[130:131]
    v_pk_mul_f32 v[68:69], v[132:133], v[132:133]
    v_pk_mul_f32 v[70:71], v[134:135], v[134:135]
    v_pk_mul_f32 v[72:73], v[136:137], v[136:137]
    v_pk_mul_f32 v[74:75], v[138:139], v[138:139]
    v_pk_mul_f32 v[76:77], v[140:141], v[140:141]
    v_pk_mul_f32 v[78:79], v[142:143], v[142:143]
    v_pk_fma_f32 v[64:65], v[64:65], v[14:15], v[12:13]
    v_pk_fma_f32 v[66:67], v[66:67], v[14:15], v[12:13]
    v_pk_fma_f32 v[68:69], v[68:69], v[14:15], v[12:13]
    v_pk_fma_f32 v[70:71], v[70:71], v[14:15], v[12:13]
    v_pk_fma_f32 v[72:73], v[72:73], v[14:15], v[12:13]
    v_pk_fma_f32 v[74:75], v[74:75], v[14:15], v[12:13]
    v_pk_fma_f32 v[76:77], v[76:77], v[14:15], v[12:13]
    v_pk_fma_f32 v[78:79], v[78:79], v[14:15], v[12:13]
    v_pk_mul_f32 v[64:65], v[64:65], v[128:129]
    v_pk_mul_f32 v[66:67], v[66:67], v[130:131]
    v_pk_mul_f32 v[68:69], v[68:69], v[132:133]
    v_pk_mul_f32 v[70:71], v[70:71], v[134:135]
    v_pk_mul_f32 v[72:73], v[72:73], v[136:137]
    v_pk_mul_f32 v[74:75], v[74:75], v[138:139]
    v_pk_mul_f32 v[76:77], v[76:77], v[140:141]
    v_pk_mul_f32 v[78:79], v[78:79], v[142:143]
    v_exp_f32 v64, v64
    v_exp_f32 v65, v65
    v_exp_f32 v66, v66
    v_exp_f32 v67, v67
    v_exp_f32 v68, v68
    v_exp_f32 v69, v69
    v_exp_f32 v70, v70
    v_exp_f32 v71, v71
    v_exp_f32 v72, v72
    v_exp_f32 v73, v73
    v_exp_f32 v74, v74
    v_exp_f32 v75, v75
    v_exp_f32 v76, v76
    v_exp_f32 v77, v77
    v_exp_f32 v78, v78
    v_exp_f32 v79, v79
    v_pk_add_f32 v[64:65], v[64:65], v[16:17]
    v_pk_add_f32 v[66:67], v[66:67], v[16:17]
    v_pk_add_f32 v[68:69], v[68:69], v[16:17]
    v_pk_add_f32 v[70:71], v[70:71], v[16:17]
    v_pk_add_f32 v[72:73], v[72:73], v[16:17]
    v_pk_add_f32 v[74:75], v[74:75], v[16:17]
    v_pk_add_f32 v[76:77], v[76:77], v[16:17]
    v_pk_add_f32 v[78:79], v[78:79], v[16:17]
    v_rcp_f32 v64, v64
    v_rcp_f32 v65, v65
    v_rcp_f32 v66, v66
    v_rcp_f32 v67, v67
    v_rcp_f32 v68, v68
    v_rcp_f32 v69, v69
    v_rcp_f32 v70, v70
    v_rcp_f32 v71, v71
    v_rcp_f32 v72, v72
    v_rcp_f32 v73, v73
    v_rcp_f32 v74, v74
    v_rcp_f32 v75, v75
    v_rcp_f32 v76, v76
    v_rcp_f32 v77, v77
    v_rcp_f32 v78, v78
    v_rcp_f32 v79, v79
    s_nop 0
    v_pk_mul_f32 v[128:129], v[128:129], v[64:65]
    v_pk_mul_f32 v[130:131], v[130:131], v[66:67]
    v_pk_mul_f32 v[132:133], v[132:133], v[68:69]
    v_pk_mul_f32 v[134:135], v[134:135], v[70:71]
    v_pk_mul_f32 v[136:137], v[136:137], v[72:73]
    v_pk_mul_f32 v[138:139], v[138:139], v[74:75]
    v_pk_mul_f32 v[140:141], v[140:141], v[76:77]
    v_pk_mul_f32 v[142:143], v[142:143], v[78:79]
    v_cvt_pk_bf16_f32 v96, v128, v129
    v_cvt_pk_bf16_f32 v97, v130, v131
    v_cvt_pk_bf16_f32 v98, v132, v133
    v_cvt_pk_bf16_f32 v99, v134, v135
    v_cvt_pk_bf16_f32 v100, v136, v137
    v_cvt_pk_bf16_f32 v101, v138, v139
    v_cvt_pk_bf16_f32 v102, v140, v141
    v_cvt_pk_bf16_f32 v103, v142, v143
    s_add_u32 s52, s32, 0x2c0000
    s_addc_u32 s53, s33, 0
    s_mov_b32 s54, 0x1e0000
    s_mov_b32 s55, 0x20000
    s_and_b32 s60, s4, 1
    s_lshl_b32 s61, s36, 1
    s_add_u32 s60, s60, s61
    s_mul_i32 s60, s60, 96
    s_lshl_b32 s61, s35, 2
    s_add_u32 s60, s60, s61
    s_and_b32 s61, s4, 2
    s_add_u32 s60, s60, s61
    s_lshl_b32 s60, s60, 10
    buffer_store_dwordx4 v[96:99], v10, s[52:55], s60 offen sc1
    buffer_store_dwordx4 v[100:103], v10, s[52:55], s60 offen offset:1024 sc1
    s_waitcnt vmcnt(0)
    s_barrier
    s_cmp_lg_u32 s4, 0
    s_cbranch_scc1 M_noarr_35
    s_lshl_b32 s64, s36, 8
    s_mov_b32 s56, s32
    s_mov_b32 s57, s33
    s_mov_b32 s58, 0x8a00
    s_mov_b32 s59, 0x20000
    v_mov_b32 v20, s64
    v_mov_b32 v21, 1
    s_mov_b64 exec, 1
    buffer_atomic_add v21, v20, s[56:59], 0 offen sc1
    s_mov_b64 exec, -1
M_noarr_35:
M1_end_31:
    s_barrier
    s_and_b32 s60, s34, 7
    s_lshr_b32 s61, s34, 3
    s_cmp_ge_u32 s61, 28
    s_cbranch_scc1 M2_end_36
    s_mul_hi_u32 s62, s61, 0x24924925
    s_mul_i32 s36, s62, 7
    s_sub_u32 s36, s61, s36
    s_lshl_b32 s62, s62, 3
    s_add_u32 s35, s60, s62
    v_lshrrev_b32 v1, 6, v0
    s_nop 0
    v_readfirstlane_b32 s4, v1
    v_and_b32 v1, 63, v0
    s_mul_i32 s66, s4, 20480
    s_mov_b32 s40, s24
    s_mov_b32 s41, s25
    s_mov_b32 s42, 0x600000
    s_mov_b32 s43, 0x20000
    s_add_u32 s44, s32, 0x2c0000
    s_addc_u32 s45, s33, 0
    s_mov_b32 s46, 0x1e0000
    s_mov_b32 s47, 0x20000
    s_mov_b32 s48, s16
    s_mov_b32 s49, s17
    s_mov_b32 s50, 0xc8000
    s_mov_b32 s51, 0x20000
    s_mov_b32 s64, 0
    s_mov_b32 s65, 0
    s_add_u32 m0, s66, 0
    s_add_u32 s60, s64, 0
    buffer_load_dwordx4 v224, s[40:43], s60 offen lds
    s_add_u32 m0, s66, 1024
    s_add_u32 s60, s64, 32768
    buffer_load_dwordx4 v224, s[40:43], s60 offen lds
    s_add_u32 m0, s66, 2048
    s_add_u32 s60, s64, 65536
    buffer_load_dwordx4 v224, s[40:43], s60 offen lds
    s_add_u32 m0, s66, 3072
    s_add_u32 s60, s64, 98304
    buffer_load_dwordx4 v224, s[40:43], s60 offen lds
    s_add_u32 s64, s64, 131072
    s_add_u32 m0, s66, 4096
    s_add_u32 s60, s64, 0
    buffer_load_dwordx4 v224, s[40:43], s60 offen lds
    s_add_u32 m0, s66, 5120
    s_add_u32 s60, s64, 32768
    buffer_load_dwordx4 v224, s[40:43], s60 offen lds
    s_add_u32 m0, s66, 6144
    s_add_u32 s60, s64, 65536
    buffer_load_dwordx4 v224, s[40:43], s60 offen lds
    s_add_u32 m0, s66, 7168
    s_add_u32 s60, s64, 98304
    buffer_load_dwordx4 v224, s[40:43], s60 offen lds
    s_add_u32 s64, s64, 131072
    s_mul_i32 s76, s36, 96
    s_lshr_b32 s77, s76, 6
    s_add_u32 s76, s76, 95
    s_lshr_b32 s76, s76, 6
    s_min_u32 s76, s76, 9
    v_and_b32 v112, 1, v0
    v_mov_b32 v113, s77
    v_mov_b32 v114, s76
    v_cmp_eq_u32 vcc, 0, v112
    s_nop 1
    v_cndmask_b32 v112, v114, v113, vcc
    v_lshlrev_b32 v112, 8, v112
    s_mov_b32 s56, s32
    s_mov_b32 s57, s33
    s_mov_b32 s58, 0x8a00
    s_mov_b32 s59, 0x20000
    s_cmp_lg_u32 s4, 0
    s_cbranch_scc1 POLLE_38
    s_mov_b32 s100, 0
    s_sleep 20
POLL_37:
    buffer_load_dword v113, v112, s[56:59], 0 offen sc1
    s_waitcnt vmcnt(0)
    v_cmp_ne_u32 vcc, 24, v113
    s_nop 1
    s_cmp_eq_u64 vcc, 0
    s_cbranch_scc1 POLLE_38
    s_sleep 8
    s_add_u32 s100, s100, 1
    s_cmp_lt_u32 s100, 65536
    s_cbranch_scc1 POLL_37
POLLE_38:
    s_barrier
    buffer_load_dwordx4 v[32:35], v225, s[44:47], s65 offen offset:0 sc1
    buffer_load_dwordx4 v[36:39], v226, s[44:47], s65 offen offset:0 sc1
    buffer_load_dwordx4 v[40:43], v227, s[44:47], s65 offen offset:0 sc1
    buffer_load_dwordx4 v[44:47], v225, s[44:47], s65 offen offset:1024 sc1
    buffer_load_dwordx4 v[48:51], v226, s[44:47], s65 offen offset:1024 sc1
    buffer_load_dwordx4 v[52:55], v227, s[44:47], s65 offen offset:1024 sc1
    s_add_u32 s65, s65, 2048
    buffer_load_dwordx4 v[56:59], v225, s[44:47], s65 offen offset:0 sc1
    buffer_load_dwordx4 v[60:63], v226, s[44:47], s65 offen offset:0 sc1
    buffer_load_dwordx4 v[64:67], v227, s[44:47], s65 offen offset:0 sc1
    buffer_load_dwordx4 v[68:71], v225, s[44:47], s65 offen offset:1024 sc1
    buffer_load_dwordx4 v[72:75], v226, s[44:47], s65 offen offset:1024 sc1
    buffer_load_dwordx4 v[76:79], v227, s[44:47], s65 offen offset:1024 sc1
    s_add_u32 s65, s65, 2048
    s_setprio 0
    s_mov_b32 s63, 0
    s_waitcnt vmcnt(6)
    ds_read_b64_tr_b16 v[112:113], v228 offset:0
    ds_read_b64_tr_b16 v[114:115], v228 offset:1024
    ds_read_b64_tr_b16 v[116:117], v229 offset:0
    ds_read_b64_tr_b16 v[118:119], v229 offset:1024
    ds_read_b64_tr_b16 v[120:121], v228 offset:2048
    ds_read_b64_tr_b16 v[122:123], v228 offset:3072
    ds_read_b64_tr_b16 v[124:125], v229 offset:2048
    ds_read_b64_tr_b16 v[126:127], v229 offset:3072
    s_waitcnt lgkmcnt(4)
    v_mfma_f32_32x32x16_bf16 v[128:143], v[32:35], v[112:115], 0
    v_mfma_f32_32x32x16_bf16 v[144:159], v[32:35], v[116:119], 0
    buffer_load_dwordx4 v[32:35], v225, s[44:47], s65 offen offset:0 sc1
    v_mfma_f32_32x32x16_bf16 v[160:175], v[36:39], v[112:115], 0
    v_mfma_f32_32x32x16_bf16 v[176:191], v[36:39], v[116:119], 0
    buffer_load_dwordx4 v[36:39], v226, s[44:47], s65 offen offset:0 sc1
    v_mfma_f32_32x32x16_bf16 v[192:207], v[40:43], v[112:115], 0
    v_mfma_f32_32x32x16_bf16 v[208:223], v[40:43], v[116:119], 0
    buffer_load_dwordx4 v[40:43], v227, s[44:47], s65 offen offset:0 sc1
    s_waitcnt lgkmcnt(0)
    v_mfma_f32_32x32x16_bf16 v[128:143], v[44:47], v[120:123], v[128:143]
    s_add_u32 m0, s66, 0
    s_add_u32 s60, s64, 0
    buffer_load_dwordx4 v224, s[40:43], s60 offen lds
    v_mfma_f32_32x32x16_bf16 v[144:159], v[44:47], v[124:127], v[144:159]
    buffer_load_dwordx4 v[44:47], v225, s[44:47], s65 offen offset:1024 sc1
    v_mfma_f32_32x32x16_bf16 v[160:175], v[48:51], v[120:123], v[160:175]
    s_add_u32 m0, s66, 1024
    s_add_u32 s60, s64, 32768
    buffer_load_dwordx4 v224, s[40:43], s60 offen lds
    v_mfma_f32_32x32x16_bf16 v[176:191], v[48:51], v[124:127], v[176:191]
    buffer_load_dwordx4 v[48:51], v226, s[44:47], s65 offen offset:1024 sc1
    v_mfma_f32_32x32x16_bf16 v[192:207], v[52:55], v[120:123], v[192:207]
    s_add_u32 m0, s66, 2048
    s_add_u32 s60, s64, 65536
    buffer_load_dwordx4 v224, s[40:43], s60 offen lds
    v_mfma_f32_32x32x16_bf16 v[208:223], v[52:55], v[124:127], v[208:223]
    s_add_u32 m0, s66, 3072
    s_add_u32 s60, s64, 98304
    buffer_load_dwordx4 v224, s[40:43], s60 offen lds
    buffer_load_dwordx4 v[52:55], v227, s[44:47], s65 offen offset:1024 sc1
    s_add_u32 s64, s64, 131072
    s_add_u32 s65, s65, 2048
    s_waitcnt vmcnt(10)
    ds_read_b64_tr_b16 v[112:113], v228 offset:4096
    ds_read_b64_tr_b16 v[114:115], v228 offset:5120
    ds_read_b64_tr_b16 v[116:117], v229 offset:4096
    ds_read_b64_tr_b16 v[118:119], v229 offset:5120
    ds_read_b64_tr_b16 v[120:121], v228 offset:6144
    ds_read_b64_tr_b16 v[122:123], v228 offset:7168
    ds_read_b64_tr_b16 v[124:125], v229 offset:6144
    ds_read_b64_tr_b16 v[126:127], v229 offset:7168
    s_waitcnt lgkmcnt(4)
    v_mfma_f32_32x32x16_bf16 v[128:143], v[56:59], v[112:115], v[128:143]
    v_mfma_f32_32x32x16_bf16 v[144:159], v[56:59], v[116:119], v[144:159]
    buffer_load_dwordx4 v[56:59], v225, s[44:47], s65 offen offset:0 sc1
    v_mfma_f32_32x32x16_bf16 v[160:175], v[60:63], v[112:115], v[160:175]
    v_mfma_f32_32x32x16_bf16 v[176:191], v[60:63], v[116:119], v[176:191]
    buffer_load_dwordx4 v[60:63], v226, s[44:47], s65 offen offset:0 sc1
    v_mfma_f32_32x32x16_bf16 v[192:207], v[64:67], v[112:115], v[192:207]
    v_mfma_f32_32x32x16_bf16 v[208:223], v[64:67], v[116:119], v[208:223]
    buffer_load_dwordx4 v[64:67], v227, s[44:47], s65 offen offset:0 sc1
    s_waitcnt lgkmcnt(0)
    v_mfma_f32_32x32x16_bf16 v[128:143], v[68:71], v[120:123], v[128:143]
    s_add_u32 m0, s66, 4096
    s_add_u32 s60, s64, 0
    buffer_load_dwordx4 v224, s[40:43], s60 offen lds
    v_mfma_f32_32x32x16_bf16 v[144:159], v[68:71], v[124:127], v[144:159]
    buffer_load_dwordx4 v[68:71], v225, s[44:47], s65 offen offset:1024 sc1
    v_mfma_f32_32x32x16_bf16 v[160:175], v[72:75], v[120:123], v[160:175]
    s_add_u32 m0, s66, 5120
    s_add_u32 s60, s64, 32768
    buffer_load_dwordx4 v224, s[40:43], s60 offen lds
    v_mfma_f32_32x32x16_bf16 v[176:191], v[72:75], v[124:127], v[176:191]
    buffer_load_dwordx4 v[72:75], v226, s[44:47], s65 offen offset:1024 sc1
    v_mfma_f32_32x32x16_bf16 v[192:207], v[76:79], v[120:123], v[192:207]
    s_add_u32 m0, s66, 6144
    s_add_u32 s60, s64, 65536
    buffer_load_dwordx4 v224, s[40:43], s60 offen lds
    v_mfma_f32_32x32x16_bf16 v[208:223], v[76:79], v[124:127], v[208:223]
    s_add_u32 m0, s66, 7168
    s_add_u32 s60, s64, 98304
    buffer_load_dwordx4 v224, s[40:43], s60 offen lds
    buffer_load_dwordx4 v[76:79], v227, s[44:47], s65 offen offset:1024 sc1
    s_add_u32 s64, s64, 131072
    s_add_u32 s65, s65, 2048
M2_loop_39:
    s_waitcnt vmcnt(10)
    ds_read_b64_tr_b16 v[112:113], v228 offset:0
    ds_read_b64_tr_b16 v[114:115], v228 offset:1024
    ds_read_b64_tr_b16 v[116:117], v229 offset:0
    ds_read_b64_tr_b16 v[118:119], v229 offset:1024
    ds_read_b64_tr_b16 v[120:121], v228 offset:2048
    ds_read_b64_tr_b16 v[122:123], v228 offset:3072
    ds_read_b64_tr_b16 v[124:125], v229 offset:2048
    ds_read_b64_tr_b16 v[126:127], v229 offset:3072
    s_waitcnt lgkmcnt(4)
    v_mfma_f32_32x32x16_bf16 v[128:143], v[32:35], v[112:115], v[128:143]
    v_mfma_f32_32x32x16_bf16 v[144:159], v[32:35], v[116:119], v[144:159]
    buffer_load_dwordx4 v[32:35], v225, s[44:47], s65 offen offset:0 sc1
    v_mfma_f32_32x32x16_bf16 v[160:175], v[36:39], v[112:115], v[160:175]
    v_mfma_f32_32x32x16_bf16 v[176:191], v[36:39], v[116:119], v[176:191]
    buffer_load_dwordx4 v[36:39], v226, s[44:47], s65 offen offset:0 sc1
    v_mfma_f32_32x32x16_bf16 v[192:207], v[40:43], v[112:115], v[192:207]
    v_mfma_f32_32x32x16_bf16 v[208:223], v[40:43], v[116:119], v[208:223]
    buffer_load_dwordx4 v[40:43], v227, s[44:47], s65 offen offset:0 sc1
    s_waitcnt lgkmcnt(0)
    v_mfma_f32_32x32x16_bf16 v[128:143], v[44:47], v[120:123], v[128:143]
    s_add_u32 m0, s66, 0
    s_add_u32 s60, s64, 0
    buffer_load_dwordx4 v224, s[40:43], s60 offen lds
    v_mfma_f32_32x32x16_bf16 v[144:159], v[44:47], v[124:127], v[144:159]
    buffer_load_dwordx4 v[44:47], v225, s[44:47], s65 offen offset:1024 sc1
    v_mfma_f32_32x32x16_bf16 v[160:175], v[48:51], v[120:123], v[160:175]
    s_add_u32 m0, s66, 1024
    s_add_u32 s60, s64, 32768
    buffer_load_dwordx4 v224, s[40:43], s60 offen lds
    v_mfma_f32_32x32x16_bf16 v[176:191], v[48:51], v[124:127], v[176:191]
    buffer_load_dwordx4 v[48:51], v226, s[44:47], s65 offen offset:1024 sc1
    v_mfma_f32_32x32x16_bf16 v[192:207], v[52:55], v[120:123], v[192:207]
    s_add_u32 m0, s66, 2048
    s_add_u32 s60, s64, 65536
    buffer_load_dwordx4 v224, s[40:43], s60 offen lds
    v_mfma_f32_32x32x16_bf16 v[208:223], v[52:55], v[124:127], v[208:223]
    s_add_u32 m0, s66, 3072
    s_add_u32 s60, s64, 98304
    buffer_load_dwordx4 v224, s[40:43], s60 offen lds
    buffer_load_dwordx4 v[52:55], v227, s[44:47], s65 offen offset:1024 sc1
    s_add_u32 s64, s64, 131072
    s_add_u32 s65, s65, 2048
    s_waitcnt vmcnt(10)
    ds_read_b64_tr_b16 v[112:113], v228 offset:4096
    ds_read_b64_tr_b16 v[114:115], v228 offset:5120
    ds_read_b64_tr_b16 v[116:117], v229 offset:4096
    ds_read_b64_tr_b16 v[118:119], v229 offset:5120
    ds_read_b64_tr_b16 v[120:121], v228 offset:6144
    ds_read_b64_tr_b16 v[122:123], v228 offset:7168
    ds_read_b64_tr_b16 v[124:125], v229 offset:6144
    ds_read_b64_tr_b16 v[126:127], v229 offset:7168
    s_waitcnt lgkmcnt(4)
    v_mfma_f32_32x32x16_bf16 v[128:143], v[56:59], v[112:115], v[128:143]
    v_mfma_f32_32x32x16_bf16 v[144:159], v[56:59], v[116:119], v[144:159]
    buffer_load_dwordx4 v[56:59], v225, s[44:47], s65 offen offset:0 sc1
    v_mfma_f32_32x32x16_bf16 v[160:175], v[60:63], v[112:115], v[160:175]
    v_mfma_f32_32x32x16_bf16 v[176:191], v[60:63], v[116:119], v[176:191]
    buffer_load_dwordx4 v[60:63], v226, s[44:47], s65 offen offset:0 sc1
    v_mfma_f32_32x32x16_bf16 v[192:207], v[64:67], v[112:115], v[192:207]
    v_mfma_f32_32x32x16_bf16 v[208:223], v[64:67], v[116:119], v[208:223]
    buffer_load_dwordx4 v[64:67], v227, s[44:47], s65 offen offset:0 sc1
    s_waitcnt lgkmcnt(0)
    v_mfma_f32_32x32x16_bf16 v[128:143], v[68:71], v[120:123], v[128:143]
    s_add_u32 m0, s66, 4096
    s_add_u32 s60, s64, 0
    buffer_load_dwordx4 v224, s[40:43], s60 offen lds
    v_mfma_f32_32x32x16_bf16 v[144:159], v[68:71], v[124:127], v[144:159]
    buffer_load_dwordx4 v[68:71], v225, s[44:47], s65 offen offset:1024 sc1
    v_mfma_f32_32x32x16_bf16 v[160:175], v[72:75], v[120:123], v[160:175]
    s_add_u32 m0, s66, 5120
    s_add_u32 s60, s64, 32768
    buffer_load_dwordx4 v224, s[40:43], s60 offen lds
    v_mfma_f32_32x32x16_bf16 v[176:191], v[72:75], v[124:127], v[176:191]
    buffer_load_dwordx4 v[72:75], v226, s[44:47], s65 offen offset:1024 sc1
    v_mfma_f32_32x32x16_bf16 v[192:207], v[76:79], v[120:123], v[192:207]
    s_add_u32 m0, s66, 6144
    s_add_u32 s60, s64, 65536
    buffer_load_dwordx4 v224, s[40:43], s60 offen lds
    v_mfma_f32_32x32x16_bf16 v[208:223], v[76:79], v[124:127], v[208:223]
    s_add_u32 m0, s66, 7168
    s_add_u32 s60, s64, 98304
    buffer_load_dwordx4 v224, s[40:43], s60 offen lds
    buffer_load_dwordx4 v[76:79], v227, s[44:47], s65 offen offset:1024 sc1
    s_add_u32 s64, s64, 131072
    s_add_u32 s65, s65, 2048
    s_add_u32 s63, s63, 1
    s_cmp_lt_u32 s63, 4
    s_cbranch_scc1 M2_loop_39
    s_waitcnt vmcnt(10)
    ds_read_b64_tr_b16 v[112:113], v228 offset:0
    ds_read_b64_tr_b16 v[114:115], v228 offset:1024
    ds_read_b64_tr_b16 v[116:117], v229 offset:0
    ds_read_b64_tr_b16 v[118:119], v229 offset:1024
    ds_read_b64_tr_b16 v[120:121], v228 offset:2048
    ds_read_b64_tr_b16 v[122:123], v228 offset:3072
    ds_read_b64_tr_b16 v[124:125], v229 offset:2048
    ds_read_b64_tr_b16 v[126:127], v229 offset:3072
    s_waitcnt lgkmcnt(4)
    v_mfma_f32_32x32x16_bf16 v[128:143], v[32:35], v[112:115], v[128:143]
    v_mfma_f32_32x32x16_bf16 v[144:159], v[32:35], v[116:119], v[144:159]
    v_mfma_f32_32x32x16_bf16 v[160:175], v[36:39], v[112:115], v[160:175]
    v_mfma_f32_32x32x16_bf16 v[176:191], v[36:39], v[116:119], v[176:191]
    v_mfma_f32_32x32x16_bf16 v[192:207], v[40:43], v[112:115], v[192:207]
    v_mfma_f32_32x32x16_bf16 v[208:223], v[40:43], v[116:119], v[208:223]
    s_waitcnt lgkmcnt(0)
    v_mfma_f32_32x32x16_bf16 v[128:143], v[44:47], v[120:123], v[128:143]
    v_mfma_f32_32x32x16_bf16 v[144:159], v[44:47], v[124:127], v[144:159]
    v_mfma_f32_32x32x16_bf16 v[160:175], v[48:51], v[120:123], v[160:175]
    v_mfma_f32_32x32x16_bf16 v[176:191], v[48:51], v[124:127], v[176:191]
    v_mfma_f32_32x32x16_bf16 v[192:207], v[52:55], v[120:123], v[192:207]
    v_mfma_f32_32x32x16_bf16 v[208:223], v[52:55], v[124:127], v[208:223]
    s_waitcnt vmcnt(0)
    ds_read_b64_tr_b16 v[112:113], v228 offset:4096
    ds_read_b64_tr_b16 v[114:115], v228 offset:5120
    ds_read_b64_tr_b16 v[116:117], v229 offset:4096
    ds_read_b64_tr_b16 v[118:119], v229 offset:5120
    ds_read_b64_tr_b16 v[120:121], v228 offset:6144
    ds_read_b64_tr_b16 v[122:123], v228 offset:7168
    ds_read_b64_tr_b16 v[124:125], v229 offset:6144
    ds_read_b64_tr_b16 v[126:127], v229 offset:7168
    s_waitcnt lgkmcnt(4)
    v_mfma_f32_32x32x16_bf16 v[128:143], v[56:59], v[112:115], v[128:143]
    v_mfma_f32_32x32x16_bf16 v[144:159], v[56:59], v[116:119], v[144:159]
    v_mfma_f32_32x32x16_bf16 v[160:175], v[60:63], v[112:115], v[160:175]
    v_mfma_f32_32x32x16_bf16 v[176:191], v[60:63], v[116:119], v[176:191]
    v_mfma_f32_32x32x16_bf16 v[192:207], v[64:67], v[112:115], v[192:207]
    v_mfma_f32_32x32x16_bf16 v[208:223], v[64:67], v[116:119], v[208:223]
    s_waitcnt lgkmcnt(0)
    v_mfma_f32_32x32x16_bf16 v[128:143], v[68:71], v[120:123], v[128:143]
    v_mfma_f32_32x32x16_bf16 v[144:159], v[68:71], v[124:127], v[144:159]
    v_mfma_f32_32x32x16_bf16 v[160:175], v[72:75], v[120:123], v[160:175]
    v_mfma_f32_32x32x16_bf16 v[176:191], v[72:75], v[124:127], v[176:191]
    v_mfma_f32_32x32x16_bf16 v[192:207], v[76:79], v[120:123], v[192:207]
    v_mfma_f32_32x32x16_bf16 v[208:223], v[76:79], v[124:127], v[208:223]
    s_setprio 2
    s_mov_b32 s56, s8
    s_mov_b32 s57, s9
    s_mov_b32 s58, 0x280000
    s_mov_b32 s59, 0x20000
    buffer_load_dwordx2 v[18:19], v236, s[56:59], 0 offen offset:0
    buffer_load_dwordx2 v[20:21], v237, s[56:59], 0 offen offset:0
    buffer_load_dwordx2 v[22:23], v236, s[56:59], 0 offen offset:64
    buffer_load_dwordx2 v[24:25], v237, s[56:59], 0 offen offset:64
    buffer_load_dwordx2 v[26:27], v236, s[56:59], 0 offen offset:128
    buffer_load_dwordx2 v[28:29], v237, s[56:59], 0 offen offset:128
    s_mov_b32 s56, s26
    s_mov_b32 s57, s27
    s_mov_b32 s58, 0x1000
    s_mov_b32 s59, 0x20000
    buffer_load_ushort v31, v30, s[56:59], 0 offen offset:64
    buffer_load_ushort v30, v30, s[56:59], 0 offen
    s_mov_b32 s60, 0
    s_add_u32 m0, s66, 0
    s_nop 0
    buffer_load_dwordx4 v230, s[48:51], s60 offen lds
    s_add_u32 m0, s66, 1024
    s_nop 0
    buffer_load_dwordx4 v231, s[48:51], s60 offen lds
    s_add_u32 m0, s66, 2048
    s_nop 0
    buffer_load_dwordx4 v232, s[48:51], s60 offen lds
    s_mov_b32 s60, 20480
    s_add_u32 m0, s66, 3072
    s_nop 0
    buffer_load_dwordx4 v230, s[48:51], s60 offen lds
    s_add_u32 m0, s66, 4096
    s_nop 0
    buffer_load_dwordx4 v231, s[48:51], s60 offen lds
    s_add_u32 m0, s66, 5120
    s_nop 0
    buffer_load_dwordx4 v232, s[48:51], s60 offen lds
    s_mov_b32 s60, 40960
    s_add_u32 m0, s66, 6144
    s_nop 0
    buffer_load_dwordx4 v230, s[48:51], s60 offen lds
    s_add_u32 m0, s66, 7168
    s_nop 0
    buffer_load_dwordx4 v231, s[48:51], s60 offen lds
    s_add_u32 m0, s66, 8192
    s_nop 0
    buffer_load_dwordx4 v232, s[48:51], s60 offen lds
    s_mov_b32 s60, 61440
    s_add_u32 m0, s66, 9216
    s_nop 0
    buffer_load_dwordx4 v230, s[48:51], s60 offen lds
    s_add_u32 m0, s66, 10240
    s_nop 0
    buffer_load_dwordx4 v231, s[48:51], s60 offen lds
    s_add_u32 m0, s66, 11264
    s_nop 0
    buffer_load_dwordx4 v232, s[48:51], s60 offen lds
    s_mov_b32 s60, 81920
    s_add_u32 m0, s66, 12288
    s_nop 0
    buffer_load_dwordx4 v230, s[48:51], s60 offen lds
    s_add_u32 m0, s66, 13312
    s_nop 0
    buffer_load_dwordx4 v231, s[48:51], s60 offen lds
    s_add_u32 m0, s66, 14336
    s_nop 0
    buffer_load_dwordx4 v232, s[48:51], s60 offen lds
    s_mov_b32 s60, 102400
    s_add_u32 m0, s66, 15360
    s_nop 0
    buffer_load_dwordx4 v230, s[48:51], s60 offen lds
    s_add_u32 m0, s66, 16384
    s_nop 0
    buffer_load_dwordx4 v231, s[48:51], s60 offen lds
    s_add_u32 m0, s66, 17408
    s_nop 0
    buffer_load_dwordx4 v232, s[48:51], s60 offen lds
    s_waitcnt vmcnt(15)
    ds_read_b64_tr_b16 v[112:113], v233 offset:0
    ds_read_b64_tr_b16 v[114:115], v233 offset:768
    ds_read_b64_tr_b16 v[116:117], v233 offset:64
    ds_read_b64_tr_b16 v[118:119], v233 offset:832
    ds_read_b64_tr_b16 v[120:121], v233 offset:128
    ds_read_b64_tr_b16 v[122:123], v233 offset:896
    s_lshl_b32 s76, s35, 2
    v_and_b32 v124, 3, v0
    v_add_u32 v124, s76, v124
    v_lshlrev_b32 v124, 7, v124
    s_add_u32 s56, s32, 0x4a00
    s_addc_u32 s57, s33, 0
    s_mov_b32 s58, 0x4000
    s_mov_b32 s59, 0x20000
    s_cmp_lg_u32 s4, 0
    s_cbranch_scc1 POLLE_41
    s_mov_b32 s100, 0
POLL_40:
    buffer_load_dword v125, v124, s[56:59], 0 offen sc1
    s_waitcnt vmcnt(0)
    v_cmp_ne_u32 vcc, 2, v125
    s_nop 1
    s_cmp_eq_u64 vcc, 0
    s_cbranch_scc1 POLLE_41
    s_sleep 2
    s_add_u32 s100, s100, 1
    s_cmp_lt_u32 s100, 65536
    s_cbranch_scc1 POLL_40
POLLE_41:
    s_barrier
    s_add_u32 s52, s32, 0x4a0000
    s_addc_u32 s53, s33, 0
    s_mov_b32 s54, 0x280000
    s_mov_b32 s55, 0x20000
    s_mov_b32 s60, 0
    buffer_load_dwordx4 v[32:35], v234, s[52:55], s60 offen sc1
    buffer_load_dwordx4 v[36:39], v235, s[52:55], s60 offen sc1
    s_mov_b32 s60, 1024
    buffer_load_dwordx4 v[40:43], v234, s[52:55], s60 offen sc1
    buffer_load_dwordx4 v[44:47], v235, s[52:55], s60 offen sc1
    s_mov_b32 s60, 2048
    buffer_load_dwordx4 v[48:51], v234, s[52:55], s60 offen sc1
    buffer_load_dwordx4 v[52:55], v235, s[52:55], s60 offen sc1
    s_mov_b32 s60, 3072
    buffer_load_dwordx4 v[56:59], v234, s[52:55], s60 offen sc1
    buffer_load_dwordx4 v[60:63], v235, s[52:55], s60 offen sc1
    s_mov_b32 s60, 4096
    buffer_load_dwordx4 v[64:67], v234, s[52:55], s60 offen sc1
    buffer_load_dwordx4 v[68:71], v235, s[52:55], s60 offen sc1
    s_mov_b32 s60, 5120
    buffer_load_dwordx4 v[72:75], v234, s[52:55], s60 offen sc1
    buffer_load_dwordx4 v[76:79], v235, s[52:55], s60 offen sc1
    s_mov_b32 s60, 6144
    buffer_load_dwordx4 v[80:83], v234, s[52:55], s60 offen sc1
    buffer_load_dwordx4 v[84:87], v235, s[52:55], s60 offen sc1
    s_mov_b32 s60, 7168
    buffer_load_dwordx4 v[88:91], v234, s[52:55], s60 offen sc1
    buffer_load_dwordx4 v[92:95], v235, s[52:55], s60 offen sc1
    s_mov_b32 s60, 8192
    buffer_load_dwordx4 v[96:99], v234, s[52:55], s60 offen sc1
    buffer_load_dwordx4 v[100:103], v235, s[52:55], s60 offen sc1
    s_mov_b32 s60, 9216
    buffer_load_dwordx4 v[104:107], v234, s[52:55], s60 offen sc1
    buffer_load_dwordx4 v[108:111], v235, s[52:55], s60 offen sc1
    s_waitcnt vmcnt(18)
    ds_read_b64_tr_b16 v[4:5], v233 offset:3072
    ds_read_b64_tr_b16 v[6:7], v233 offset:3840
    ds_read_b64_tr_b16 v[8:9], v233 offset:3136
    ds_read_b64_tr_b16 v[10:11], v233 offset:3904
    ds_read_b64_tr_b16 v[12:13], v233 offset:3200
    ds_read_b64_tr_b16 v[14:15], v233 offset:3968
    s_waitcnt lgkmcnt(6)
    v_mfma_f32_32x32x16_bf16 v[128:143], v[112:115], v[32:35], v[128:143]
    v_mfma_f32_32x32x16_bf16 v[144:159], v[112:115], v[36:39], v[144:159]
    v_mfma_f32_32x32x16_bf16 v[160:175], v[116:119], v[32:35], v[160:175]
    v_mfma_f32_32x32x16_bf16 v[176:191], v[116:119], v[36:39], v[176:191]
    v_mfma_f32_32x32x16_bf16 v[192:207], v[120:123], v[32:35], v[192:207]
    v_mfma_f32_32x32x16_bf16 v[208:223], v[120:123], v[36:39], v[208:223]
    s_mov_b32 s60, 122880
    s_add_u32 m0, s66, 0
    s_nop 0
    buffer_load_dwordx4 v230, s[48:51], s60 offen lds
    s_add_u32 m0, s66, 1024
    s_nop 0
    buffer_load_dwordx4 v231, s[48:51], s60 offen lds
    s_add_u32 m0, s66, 2048
    s_nop 0
    buffer_load_dwordx4 v232, s[48:51], s60 offen lds
    s_waitcnt vmcnt(19)
    ds_read_b64_tr_b16 v[112:113], v233 offset:6144
    ds_read_b64_tr_b16 v[114:115], v233 offset:6912
    ds_read_b64_tr_b16 v[116:117], v233 offset:6208
    ds_read_b64_tr_b16 v[118:119], v233 offset:6976
    ds_read_b64_tr_b16 v[120:121], v233 offset:6272
    ds_read_b64_tr_b16 v[122:123], v233 offset:7040
    s_waitcnt lgkmcnt(6)
    v_mfma_f32_32x32x16_bf16 v[128:143], v[4:7], v[40:43], v[128:143]
    v_mfma_f32_32x32x16_bf16 v[144:159], v[4:7], v[44:47], v[144:159]
    v_mfma_f32_32x32x16_bf16 v[160:175], v[8:11], v[40:43], v[160:175]
    v_mfma_f32_32x32x16_bf16 v[176:191], v[8:11], v[44:47], v[176:191]
    v_mfma_f32_32x32x16_bf16 v[192:207], v[12:15], v[40:43], v[192:207]
    v_mfma_f32_32x32x16_bf16 v[208:223], v[12:15], v[44:47], v[208:223]
    s_mov_b32 s60, 143360
    s_add_u32 m0, s66, 3072
    s_nop 0
    buffer_load_dwordx4 v230, s[48:51], s60 offen lds
    s_add_u32 m0, s66, 4096
    s_nop 0
    buffer_load_dwordx4 v231, s[48:51], s60 offen lds
    s_add_u32 m0, s66, 5120
    s_nop 0
    buffer_load_dwordx4 v232, s[48:51], s60 offen lds
    s_waitcnt vmcnt(20)
    ds_read_b64_tr_b16 v[4:5], v233 offset:9216
    ds_read_b64_tr_b16 v[6:7], v233 offset:9984
    ds_read_b64_tr_b16 v[8:9], v233 offset:9280
    ds_read_b64_tr_b16 v[10:11], v233 offset:10048
    ds_read_b64_tr_b16 v[12:13], v233 offset:9344
    ds_read_b64_tr_b16 v[14:15], v233 offset:10112
    s_waitcnt lgkmcnt(6)
    v_mfma_f32_32x32x16_bf16 v[128:143], v[112:115], v[48:51], v[128:143]
    v_mfma_f32_32x32x16_bf16 v[144:159], v[112:115], v[52:55], v[144:159]
    v_mfma_f32_32x32x16_bf16 v[160:175], v[116:119], v[48:51], v[160:175]
    v_mfma_f32_32x32x16_bf16 v[176:191], v[116:119], v[52:55], v[176:191]
    v_mfma_f32_32x32x16_bf16 v[192:207], v[120:123], v[48:51], v[192:207]
    v_mfma_f32_32x32x16_bf16 v[208:223], v[120:123], v[52:55], v[208:223]
    s_mov_b32 s60, 163840
    s_add_u32 m0, s66, 6144
    s_nop 0
    buffer_load_dwordx4 v230, s[48:51], s60 offen lds
    s_add_u32 m0, s66, 7168
    s_nop 0
    buffer_load_dwordx4 v231, s[48:51], s60 offen lds
    s_add_u32 m0, s66, 8192
    s_nop 0
    buffer_load_dwordx4 v232, s[48:51], s60 offen lds
    s_waitcnt vmcnt(21)
    ds_read_b64_tr_b16 v[112:113], v233 offset:12288
    ds_read_b64_tr_b16 v[114:115], v233 offset:13056
    ds_read_b64_tr_b16 v[116:117], v233 offset:12352
    ds_read_b64_tr_b16 v[118:119], v233 offset:13120
    ds_read_b64_tr_b16 v[120:121], v233 offset:12416
    ds_read_b64_tr_b16 v[122:123], v233 offset:13184
    s_waitcnt lgkmcnt(6)
    v_mfma_f32_32x32x16_bf16 v[128:143], v[4:7], v[56:59], v[128:143]
    v_mfma_f32_32x32x16_bf16 v[144:159], v[4:7], v[60:63], v[144:159]
    v_mfma_f32_32x32x16_bf16 v[160:175], v[8:11], v[56:59], v[160:175]
    v_mfma_f32_32x32x16_bf16 v[176:191], v[8:11], v[60:63], v[176:191]
    v_mfma_f32_32x32x16_bf16 v[192:207], v[12:15], v[56:59], v[192:207]
    v_mfma_f32_32x32x16_bf16 v[208:223], v[12:15], v[60:63], v[208:223]
    s_mov_b32 s60, 184320
    s_add_u32 m0, s66, 9216
    s_nop 0
    buffer_load_dwordx4 v230, s[48:51], s60 offen lds
    s_add_u32 m0, s66, 10240
    s_nop 0
    buffer_load_dwordx4 v231, s[48:51], s60 offen lds
    s_add_u32 m0, s66, 11264
    s_nop 0
    buffer_load_dwordx4 v232, s[48:51], s60 offen lds
    s_waitcnt vmcnt(22)
    ds_read_b64_tr_b16 v[4:5], v233 offset:15360
    ds_read_b64_tr_b16 v[6:7], v233 offset:16128
    ds_read_b64_tr_b16 v[8:9], v233 offset:15424
    ds_read_b64_tr_b16 v[10:11], v233 offset:16192
    ds_read_b64_tr_b16 v[12:13], v233 offset:15488
    ds_read_b64_tr_b16 v[14:15], v233 offset:16256
    s_waitcnt lgkmcnt(6)
    v_mfma_f32_32x32x16_bf16 v[128:143], v[112:115], v[64:67], v[128:143]
    v_mfma_f32_32x32x16_bf16 v[144:159], v[112:115], v[68:71], v[144:159]
    v_mfma_f32_32x32x16_bf16 v[160:175], v[116:119], v[64:67], v[160:175]
    v_mfma_f32_32x32x16_bf16 v[176:191], v[116:119], v[68:71], v[176:191]
    v_mfma_f32_32x32x16_bf16 v[192:207], v[120:123], v[64:67], v[192:207]
    v_mfma_f32_32x32x16_bf16 v[208:223], v[120:123], v[68:71], v[208:223]
    s_waitcnt vmcnt(9)
    ds_read_b64_tr_b16 v[112:113], v233 offset:0
    ds_read_b64_tr_b16 v[114:115], v233 offset:768
    ds_read_b64_tr_b16 v[116:117], v233 offset:64
    ds_read_b64_tr_b16 v[118:119], v233 offset:832
    ds_read_b64_tr_b16 v[120:121], v233 offset:128
    ds_read_b64_tr_b16 v[122:123], v233 offset:896
    s_waitcnt lgkmcnt(6)
    v_mfma_f32_32x32x16_bf16 v[128:143], v[4:7], v[72:75], v[128:143]
    v_mfma_f32_32x32x16_bf16 v[144:159], v[4:7], v[76:79], v[144:159]
    v_mfma_f32_32x32x16_bf16 v[160:175], v[8:11], v[72:75], v[160:175]
    v_mfma_f32_32x32x16_bf16 v[176:191], v[8:11], v[76:79], v[176:191]
    v_mfma_f32_32x32x16_bf16 v[192:207], v[12:15], v[72:75], v[192:207]
    v_mfma_f32_32x32x16_bf16 v[208:223], v[12:15], v[76:79], v[208:223]
    s_waitcnt vmcnt(6)
    ds_read_b64_tr_b16 v[4:5], v233 offset:3072
    ds_read_b64_tr_b16 v[6:7], v233 offset:3840
    ds_read_b64_tr_b16 v[8:9], v233 offset:3136
    ds_read_b64_tr_b16 v[10:11], v233 offset:3904
    ds_read_b64_tr_b16 v[12:13], v233 offset:3200
    ds_read_b64_tr_b16 v[14:15], v233 offset:3968
    s_waitcnt lgkmcnt(6)
    v_mfma_f32_32x32x16_bf16 v[128:143], v[112:115], v[80:83], v[128:143]
    v_mfma_f32_32x32x16_bf16 v[144:159], v[112:115], v[84:87], v[144:159]
    v_mfma_f32_32x32x16_bf16 v[160:175], v[116:119], v[80:83], v[160:175]
    v_mfma_f32_32x32x16_bf16 v[176:191], v[116:119], v[84:87], v[176:191]
    v_mfma_f32_32x32x16_bf16 v[192:207], v[120:123], v[80:83], v[192:207]
    v_mfma_f32_32x32x16_bf16 v[208:223], v[120:123], v[84:87], v[208:223]
    s_waitcnt vmcnt(3)
    ds_read_b64_tr_b16 v[112:113], v233 offset:6144
    ds_read_b64_tr_b16 v[114:115], v233 offset:6912
    ds_read_b64_tr_b16 v[116:117], v233 offset:6208
    ds_read_b64_tr_b16 v[118:119], v233 offset:6976
    ds_read_b64_tr_b16 v[120:121], v233 offset:6272
    ds_read_b64_tr_b16 v[122:123], v233 offset:7040
    s_waitcnt lgkmcnt(6)
    v_mfma_f32_32x32x16_bf16 v[128:143], v[4:7], v[88:91], v[128:143]
    v_mfma_f32_32x32x16_bf16 v[144:159], v[4:7], v[92:95], v[144:159]
    v_mfma_f32_32x32x16_bf16 v[160:175], v[8:11], v[88:91], v[160:175]
    v_mfma_f32_32x32x16_bf16 v[176:191], v[8:11], v[92:95], v[176:191]
    v_mfma_f32_32x32x16_bf16 v[192:207], v[12:15], v[88:91], v[192:207]
    v_mfma_f32_32x32x16_bf16 v[208:223], v[12:15], v[92:95], v[208:223]
    s_waitcnt vmcnt(0)
    ds_read_b64_tr_b16 v[4:5], v233 offset:9216
    ds_read_b64_tr_b16 v[6:7], v233 offset:9984
    ds_read_b64_tr_b16 v[8:9], v233 offset:9280
    ds_read_b64_tr_b16 v[10:11], v233 offset:10048
    ds_read_b64_tr_b16 v[12:13], v233 offset:9344
    ds_read_b64_tr_b16 v[14:15], v233 offset:10112
    s_waitcnt lgkmcnt(6)
    v_mfma_f32_32x32x16_bf16 v[128:143], v[112:115], v[96:99], v[128:143]
    v_mfma_f32_32x32x16_bf16 v[144:159], v[112:115], v[100:103], v[144:159]
    v_mfma_f32_32x32x16_bf16 v[160:175], v[116:119], v[96:99], v[160:175]
    v_mfma_f32_32x32x16_bf16 v[176:191], v[116:119], v[100:103], v[176:191]
    v_mfma_f32_32x32x16_bf16 v[192:207], v[120:123], v[96:99], v[192:207]
    v_mfma_f32_32x32x16_bf16 v[208:223], v[120:123], v[100:103], v[208:223]
    s_waitcnt vmcnt(0)
    s_waitcnt lgkmcnt(0)
    v_mfma_f32_32x32x16_bf16 v[128:143], v[4:7], v[104:107], v[128:143]
    v_mfma_f32_32x32x16_bf16 v[144:159], v[4:7], v[108:111], v[144:159]
    v_mfma_f32_32x32x16_bf16 v[160:175], v[8:11], v[104:107], v[160:175]
    v_mfma_f32_32x32x16_bf16 v[176:191], v[8:11], v[108:111], v[176:191]
    v_mfma_f32_32x32x16_bf16 v[192:207], v[12:15], v[104:107], v[192:207]
    v_mfma_f32_32x32x16_bf16 v[208:223], v[12:15], v[108:111], v[208:223]
    s_nop 11
    s_barrier
    v_lshlrev_b32 v224, 4, v1
    s_add_u32 s60, s4, 1
    s_and_b32 s60, s60, 3
    s_mul_i32 s60, s60, 18432
    v_add_u32 v225, s60, v224
    ds_write_b128 v225, v[132:135] offset:0
    ds_write_b128 v225, v[148:151] offset:1024
    ds_write_b128 v225, v[164:167] offset:2048
    ds_write_b128 v225, v[180:183] offset:3072
    ds_write_b128 v225, v[196:199] offset:4096
    ds_write_b128 v225, v[212:215] offset:5120
    s_add_u32 s60, s4, 2
    s_and_b32 s60, s60, 3
    s_mul_i32 s60, s60, 18432
    v_add_u32 v225, s60, v224
    ds_write_b128 v225, v[136:139] offset:6144
    ds_write_b128 v225, v[152:155] offset:7168
    ds_write_b128 v225, v[168:171] offset:8192
    ds_write_b128 v225, v[184:187] offset:9216
    ds_write_b128 v225, v[200:203] offset:10240
    ds_write_b128 v225, v[216:219] offset:11264
    s_add_u32 s60, s4, 3
    s_and_b32 s60, s60, 3
    s_mul_i32 s60, s60, 18432
    v_add_u32 v225, s60, v224
    ds_write_b128 v225, v[140:143] offset:12288
    ds_write_b128 v225, v[156:159] offset:13312
    ds_write_b128 v225, v[172:175] offset:14336
    ds_write_b128 v225, v[188:191] offset:15360
    ds_write_b128 v225, v[204:207] offset:16384
    ds_write_b128 v225, v[220:223] offset:17408
    s_waitcnt lgkmcnt(0)
    s_barrier
    s_mul_i32 s60, s4, 18432
    v_add_u32 v225, s60, v224
    ds_read_b128 v[32:35], v225 offset:0
    ds_read_b128 v[36:39], v225 offset:1024
    ds_read_b128 v[40:43], v225 offset:2048
    ds_read_b128 v[44:47], v225 offset:3072
    ds_read_b128 v[48:51], v225 offset:4096
    ds_read_b128 v[52:55], v225 offset:5120
    ds_read_b128 v[56:59], v225 offset:6144
    ds_read_b128 v[60:63], v225 offset:7168
    ds_read_b128 v[64:67], v225 offset:8192
    ds_read_b128 v[68:71], v225 offset:9216
    ds_read_b128 v[72:75], v225 offset:10240
    ds_read_b128 v[76:79], v225 offset:11264
    ds_read_b128 v[80:83], v225 offset:12288
    ds_read_b128 v[84:87], v225 offset:13312
    ds_read_b128 v[88:91], v225 offset:14336
    ds_read_b128 v[92:95], v225 offset:15360
    ds_read_b128 v[96:99], v225 offset:16384
    ds_read_b128 v[100:103], v225 offset:17408
    v_lshlrev_b32 v116, 16, v30
    v_lshlrev_b32 v117, 16, v30
    v_lshlrev_b32 v118, 16, v31
    v_lshlrev_b32 v119, 16, v31
    s_mov_b32 s61, 0xffff0000
    s_mov_b32 s56, s28
    s_mov_b32 s57, s29
    s_mov_b32 s58, 0x280000
    s_mov_b32 s59, 0x20000
    s_waitcnt lgkmcnt(0)
    v_pk_add_f32 v[32:33], v[32:33], v[56:57]
    v_pk_add_f32 v[128:129], v[128:129], v[80:81]
    v_pk_add_f32 v[34:35], v[34:35], v[58:59]
    v_pk_add_f32 v[130:131], v[130:131], v[82:83]
    v_lshlrev_b32 v112, 16, v18
    v_and_b32 v113, s61, v18
    v_lshlrev_b32 v114, 16, v19
    v_and_b32 v115, s61, v19
    v_pk_add_f32 v[128:129], v[128:129], v[32:33]
    v_pk_add_f32 v[112:113], v[112:113], v[116:117]
    v_pk_add_f32 v[130:131], v[130:131], v[34:35]
    v_pk_add_f32 v[114:115], v[114:115], v[116:117]
    v_pk_add_f32 v[128:129], v[128:129], v[112:113]
    v_pk_add_f32 v[130:131], v[130:131], v[114:115]
    v_cvt_pk_bf16_f32 v132, v128, v129
    v_cvt_pk_bf16_f32 v133, v130, v131
    buffer_store_dwordx2 v[132:133], v236, s[56:59], 0 offen offset:0
    v_pk_add_f32 v[36:37], v[36:37], v[60:61]
    v_pk_add_f32 v[144:145], v[144:145], v[84:85]
    v_pk_add_f32 v[38:39], v[38:39], v[62:63]
    v_pk_add_f32 v[146:147], v[146:147], v[86:87]
    v_lshlrev_b32 v112, 16, v20
    v_and_b32 v113, s61, v20
    v_lshlrev_b32 v114, 16, v21
    v_and_b32 v115, s61, v21
    v_pk_add_f32 v[144:145], v[144:145], v[36:37]
    v_pk_add_f32 v[112:113], v[112:113], v[118:119]
    v_pk_add_f32 v[146:147], v[146:147], v[38:39]
    v_pk_add_f32 v[114:115], v[114:115], v[118:119]
    v_pk_add_f32 v[144:145], v[144:145], v[112:113]
    v_pk_add_f32 v[146:147], v[146:147], v[114:115]
    v_cvt_pk_bf16_f32 v148, v144, v145
    v_cvt_pk_bf16_f32 v149, v146, v147
    buffer_store_dwordx2 v[148:149], v237, s[56:59], 0 offen offset:0
    v_pk_add_f32 v[40:41], v[40:41], v[64:65]
    v_pk_add_f32 v[160:161], v[160:161], v[88:89]
    v_pk_add_f32 v[42:43], v[42:43], v[66:67]
    v_pk_add_f32 v[162:163], v[162:163], v[90:91]
    v_lshlrev_b32 v112, 16, v22
    v_and_b32 v113, s61, v22
    v_lshlrev_b32 v114, 16, v23
    v_and_b32 v115, s61, v23
    v_pk_add_f32 v[160:161], v[160:161], v[40:41]
    v_pk_add_f32 v[112:113], v[112:113], v[116:117]
    v_pk_add_f32 v[162:163], v[162:163], v[42:43]
    v_pk_add_f32 v[114:115], v[114:115], v[116:117]
    v_pk_add_f32 v[160:161], v[160:161], v[112:113]
    v_pk_add_f32 v[162:163], v[162:163], v[114:115]
    v_cvt_pk_bf16_f32 v164, v160, v161
    v_cvt_pk_bf16_f32 v165, v162, v163
    buffer_store_dwordx2 v[164:165], v236, s[56:59], 0 offen offset:64
    v_pk_add_f32 v[44:45], v[44:45], v[68:69]
    v_pk_add_f32 v[176:177], v[176:177], v[92:93]
    v_pk_add_f32 v[46:47], v[46:47], v[70:71]
    v_pk_add_f32 v[178:179], v[178:179], v[94:95]
    v_lshlrev_b32 v112, 16, v24
    v_and_b32 v113, s61, v24
    v_lshlrev_b32 v114, 16, v25
    v_and_b32 v115, s61, v25
    v_pk_add_f32 v[176:177], v[176:177], v[44:45]
    v_pk_add_f32 v[112:113], v[112:113], v[118:119]
    v_pk_add_f32 v[178:179], v[178:179], v[46:47]
    v_pk_add_f32 v[114:115], v[114:115], v[118:119]
    v_pk_add_f32 v[176:177], v[176:177], v[112:113]
    v_pk_add_f32 v[178:179], v[178:179], v[114:115]
    v_cvt_pk_bf16_f32 v180, v176, v177
    v_cvt_pk_bf16_f32 v181, v178, v179
    buffer_store_dwordx2 v[180:181], v237, s[56:59], 0 offen offset:64
    s_cmp_eq_u32 s36, 6
    s_cbranch_scc1 M2_skip_42
    v_pk_add_f32 v[48:49], v[48:49], v[72:73]
    v_pk_add_f32 v[192:193], v[192:193], v[96:97]
    v_pk_add_f32 v[50:51], v[50:51], v[74:75]
    v_pk_add_f32 v[194:195], v[194:195], v[98:99]
    v_lshlrev_b32 v112, 16, v26
    v_and_b32 v113, s61, v26
    v_lshlrev_b32 v114, 16, v27
    v_and_b32 v115, s61, v27
    v_pk_add_f32 v[192:193], v[192:193], v[48:49]
    v_pk_add_f32 v[112:113], v[112:113], v[116:117]
    v_pk_add_f32 v[194:195], v[194:195], v[50:51]
    v_pk_add_f32 v[114:115], v[114:115], v[116:117]
    v_pk_add_f32 v[192:193], v[192:193], v[112:113]
    v_pk_add_f32 v[194:195], v[194:195], v[114:115]
    v_cvt_pk_bf16_f32 v196, v192, v193
    v_cvt_pk_bf16_f32 v197, v194, v195
    buffer_store_dwordx2 v[196:197], v236, s[56:59], 0 offen offset:128
    v_pk_add_f32 v[52:53], v[52:53], v[76:77]
    v_pk_add_f32 v[208:209], v[208:209], v[100:101]
    v_pk_add_f32 v[54:55], v[54:55], v[78:79]
    v_pk_add_f32 v[210:211], v[210:211], v[102:103]
    v_lshlrev_b32 v112, 16, v28
    v_and_b32 v113, s61, v28
    v_lshlrev_b32 v114, 16, v29
    v_and_b32 v115, s61, v29
    v_pk_add_f32 v[208:209], v[208:209], v[52:53]
    v_pk_add_f32 v[112:113], v[112:113], v[118:119]
    v_pk_add_f32 v[210:211], v[210:211], v[54:55]
    v_pk_add_f32 v[114:115], v[114:115], v[118:119]
    v_pk_add_f32 v[208:209], v[208:209], v[112:113]
    v_pk_add_f32 v[210:211], v[210:211], v[114:115]
    v_cvt_pk_bf16_f32 v212, v208, v209
    v_cvt_pk_bf16_f32 v213, v210, v211
    buffer_store_dwordx2 v[212:213], v237, s[56:59], 0 offen offset:128
M2_skip_42:
M2_end_36:
parallel_sum__grouped_kv_mqa__mixer_token_mlp__prompt_kernel_end:
    s_endpgm
.section .rodata,"a"
.p2align 6
.amdhsa_kernel parallel_sum__grouped_kv_mqa__mixer_token_mlp__prompt_kernel
  .amdhsa_next_free_vgpr 256
  .amdhsa_next_free_sgpr 102
  .amdhsa_accum_offset 256
  .amdhsa_group_segment_fixed_size 0
  .amdhsa_kernarg_size 104
  .amdhsa_user_sgpr_count 2
  .amdhsa_user_sgpr_kernarg_segment_ptr 1
  .amdhsa_system_sgpr_workgroup_id_x 1
.end_amdhsa_kernel
.text
```
